```python
import torch

def _softmax(x, axis=-1):
    return torch.softmax(x, dim=axis)
def _gelu(x):
    return torch.nn.functional.gelu(x, approximate="tanh")
def _silu(x):
    return torch.nn.functional.silu(x)
def _sigmoid(x):
    return torch.sigmoid(x)
def _layernorm(x, axis=-1, eps=1e-5):
    m = x.mean(dim=axis, keepdim=True)
    v = x.var(dim=axis, keepdim=True, unbiased=False)
    return (x - m) / torch.sqrt(v + eps)
def _scatter_add(tgt, idx, src, axis=0):
    return tgt.clone().index_add_(axis, idx, src)
def _segment_sum(src, seg, n):
    out = torch.zeros((n,) + src.shape[1:], dtype=src.dtype)
    return out.index_add_(0, seg, src)
def _pad(x, pw):
    flat = tuple(v for pair in reversed(pw) for v in pair)
    return torch.nn.functional.pad(x, flat)

kernel_name = 'interleave_layers__softmax_full_mha__dense_activation_mish__prompt'

def setup_inputs():

    _w = (lambda a: (lambda t: t.to(torch.bfloat16) if t.is_floating_point() else t)(torch.as_tensor(a)))
    def _A_setup():
        B, S, D = 1, 2048, 512
        return {
            "x": _w((lambda *s: torch.randn(*s, dtype=torch.bfloat16) * 0.05)(B, S, D)),
            "wqkv": _w((lambda *s: torch.randn(*s, dtype=torch.bfloat16) * 0.05)(D, 3 * D)),
            "wo": _w((lambda *s: torch.randn(*s, dtype=torch.bfloat16) * 0.05)(D, D)),
        }
    _A_in = _A_setup()

    def _B_setup():
        B, S, D, F = 1, 2048, 512, 1376
        return {
            "x": _w((lambda *s: torch.randn(*s, dtype=torch.bfloat16) * 0.05)(B, S, D)),
            "w1": _w((lambda *s: torch.randn(*s, dtype=torch.bfloat16) * 1.6)(D, F) * (D ** -0.5)),
            "b1": _w((lambda *s: torch.randn(*s, dtype=torch.bfloat16) * 0.2)(F)),
            "w2": _w((lambda *s: torch.randn(*s, dtype=torch.bfloat16) * 0.2)(F, D) * (F ** -0.5)),
        }
    _B_in = _B_setup()

    return {
        "A_x": _A_in["x"],
        "A_wqkv": _A_in["wqkv"],
        "A_wo": _A_in["wo"],
        "B_x": _B_in["x"],
        "B_w1": _B_in["w1"],
        "B_b1": _B_in["b1"],
        "B_w2": _B_in["w2"],
    }

def reference(A_x, A_wqkv, A_wo, B_x, B_w1, B_b1, B_w2):
    def _A_ref(x, wqkv, wo):
        B, S, D = x.shape
        H = 32; Dh = D // H
        qkv = (lambda x, *d: x.permute(*d))((x @ wqkv).reshape(B, S, 3, H, Dh), 2, 0, 3, 1, 4)
        q, k, v = qkv[0], qkv[1], qkv[2]
        scale = Dh ** -0.5
        scores = torch.einsum("bhqd,bhkd->bhqk", q, k) * scale
        p = _softmax(scores, axis=-1)
        o = torch.einsum("bhqk,bhkd->bhqd", p, v)
        return (lambda x, *d: x.permute(*d))(o, 0, 2, 1, 3).reshape(B, S, D) @ wo

    def _B_ref(x, w1, b1, w2):
        h = torch.einsum("bsd,df->bsf", x, w1) + b1
        sp = torch.log1p(torch.exp(-torch.abs(h))) + torch.where(h > 0, h, torch.zeros_like(h))
        act = h * torch.tanh(sp)
        return torch.einsum("bsf,fd->bsd", act, w2)

    x = A_x
    x = x + _A_ref(_layernorm(x, axis=-1), A_wqkv, A_wo)
    x = x + _B_ref(_layernorm(x, axis=-1), B_w1, B_b1, B_w2)
    x = x + _A_ref(_layernorm(x, axis=-1), A_wqkv, A_wo)
    x = x + _B_ref(_layernorm(x, axis=-1), B_w1, B_b1, B_w2)
    return x
```

```asm
; @launch grid=(256,1,1) block=(512,1,1) lds=163840
.amdgcn_target "amdgcn-amd-amdhsa--gfx950"
.text
.globl interleave_layers__softmax_full_mha__dense_activation_mish__prompt_kernel
.p2align 8
.type interleave_layers__softmax_full_mha__dense_activation_mish__prompt_kernel,@function
interleave_layers__softmax_full_mha__dense_activation_mish__prompt_kernel:
    s_load_dwordx4 s[16:19], s[0:1], 0
    s_load_dwordx4 s[44:47], s[0:1], 64
    s_cmp_ge_u32 s2, 256
    s_cbranch_scc1 ac_end
    s_memrealtime s[22:23]
    s_and_b32 s3, s2, 7
    s_lshr_b32 s4, s2, 3
    s_lshr_b32 s30, s3, 1
    s_lshl_b32 s30, s30, 2
    s_and_b32 s34, s4, 3
    s_add_u32 s30, s30, s34
    s_and_b32 s31, s3, 1
    s_lshl_b32 s31, s31, 3
    s_lshr_b32 s5, s4, 2
    s_add_u32 s31, s31, s5
    s_mov_b32 s14, 0x10000000
    s_mov_b32 s15, 0x00020000
    s_mov_b32 s10, 0x200000
    s_mov_b32 s11, 0x00020000
    s_mov_b32 s42, 0x180000
    s_mov_b32 s43, 0x00020000
    v_and_b32 v1, 63, v0
    v_lshrrev_b32 v4, 6, v0
    v_and_b32 v2, 31, v0
    v_readfirstlane_b32 s32, v4
    v_bfe_u32 v3, v0, 5, 1
    v_lshlrev_b32 v7, 4, v1
    s_lshl_b32 s28, s4, 3
    s_add_u32 s28, s28, s32
    s_getpc_b64 s[50:51]
pc_1:
    s_sub_u32 s50, s50, pc_1-interleave_layers__softmax_full_mha__dense_activation_mish__prompt_kernel
    s_subb_u32 s51, s51, 0
    s_lshl_b32 s5, s28, 7
    v_lshlrev_b32 v124, 15, v1
    v_add_u32 v124, s5, v124
    v_min_u32 v124, code_end-interleave_layers__softmax_full_mha__dense_activation_mish__prompt_kernel-4, v124
    v_mov_b32 v125, s51
    v_add_co_u32 v124, vcc, s50, v124
    s_nop 1
    v_addc_co_u32 v125, vcc, 0, v125, vcc
    global_load_dword v33, v[124:125], off
    s_mov_b32 s5, 0xaaab
    s_mov_b32 s6, 2880
    v_add_u32 v4, 0, v1
    v_mul_u32_u24 v5, s5, v4
    v_lshrrev_b32 v5, 19, v5
    v_mad_u32_u24 v180, v5, s6, v7
    v_add_u32 v4, 64, v1
    v_mul_u32_u24 v5, s5, v4
    v_lshrrev_b32 v5, 19, v5
    v_mad_u32_u24 v181, v5, s6, v7
    v_add_u32 v4, 128, v1
    v_mul_u32_u24 v5, s5, v4
    v_lshrrev_b32 v5, 19, v5
    v_mad_u32_u24 v182, v5, s6, v7
    s_and_b32 s33, s32, 3
    s_lshl_b32 s24, s30, 2
    s_add_u32 s24, s24, s33
    s_mul_i32 s35, s34, 0
    s_mul_i32 s36, s33, 49152
    s_mul_i32 s5, s31, 192
    s_add_u32 s36, s36, s5
    s_mul_i32 s37, s33, 3072
    s_add_u32 s37, s37, 81920
    s_cmp_ge_u32 s32, 4
    s_cbranch_scc1 k1_helper
    v_lshrrev_b32 v4, 3, v1
    v_and_b32 v5, 7, v0
    v_lshrrev_b32 v6, 4, v1
    v_xor_b32 v5, v5, v6
    v_lshlrev_b32 v5, 4, v5
    v_lshl_add_u32 v13, v4, 10, v5
    v_xor_b32 v14, 64, v13
    v_add_u32 v14, 7168, v14
    v_add_u32 v15, 14336, v13
    v_add_u32 v16, 14336, v14
    s_lshl_b32 s20, s24, 15
    s_mul_i32 s21, s33, 20480
    s_waitcnt lgkmcnt(0)
    s_mov_b32 s8, s16
    s_mov_b32 s9, s17
    s_mov_b32 s40, s18
    s_mov_b32 s41, s19
    s_mov_b32 s12, s46
    s_mov_b32 s13, s47
    s_mov_b32 s46, 0x100
    s_mov_b32 s47, 0x00020000
    s_xor_b32 s29, s35, 0
    s_add_u32 m0, s37, 0
    s_mul_i32 s29, s29, 196608
    s_add_u32 s29, s29, s36
    buffer_load_dwordx4 v180, s[40:43], s29 offen offset:0  lds
    buffer_load_dwordx4 v181, s[40:43], s29 offen offset:1024  lds
    buffer_load_dwordx4 v182, s[40:43], s29 offen offset:2048  lds
    s_xor_b32 s29, s35, 0
    s_add_u32 m0, s21, 0
    s_lshl_b32 s29, s29, 7
    s_add_u32 s29, s29, s20
    buffer_load_dwordx4 v13, s[8:11], s29 offen offset:0  lds
    buffer_load_dwordx4 v14, s[8:11], s29 offen offset:1024  lds
    buffer_load_dwordx4 v15, s[8:11], s29 offen offset:2048  lds
    buffer_load_dwordx4 v16, s[8:11], s29 offen offset:3072  lds
    s_lshl_b32 s22, s22, 4
    s_max_u32 s22, s22, 16
    v_mov_b32 v4, s22
    s_or_b32 s5, s2, s32
    s_cselect_b32 s5, 256, 0
    s_mov_b64 exec, 1
    buffer_store_dword v4, off, s[44:47], s5 sc1
    s_mov_b64 exec, -1
    s_mul_i32 s5, s33, 20480
    v_lshlrev_b32 v4, 7, v2
    v_add_u32 v4, s5, v4
    v_bfe_u32 v5, v0, 1, 3
    v_xor_b32 v5, v5, v3
    v_xor_b32 v6, 0, v5
    v_lshl_add_u32 v17, v6, 4, v4
    v_xor_b32 v6, 2, v5
    v_lshl_add_u32 v18, v6, 4, v4
    v_xor_b32 v6, 4, v5
    v_lshl_add_u32 v19, v6, 4, v4
    v_xor_b32 v6, 6, v5
    v_lshl_add_u32 v20, v6, 4, v4
    v_bfe_u32 v4, v0, 2, 2
    v_lshl_add_u32 v4, v3, 3, v4
    v_mul_u32_u24 v4, 192, v4
    v_bfe_u32 v5, v0, 4, 1
    v_lshl_add_u32 v4, v5, 5, v4
    v_and_b32 v5, 3, v0
    v_lshl_add_u32 v4, v5, 3, v4
    v_add_u32 v8, 81920, v4
    v_lshlrev_b32 v9, 4, v3
    v_add_u32 v9, 143360, v9
    v_lshlrev_b32 v10, 4, v2
    s_lshl_b32 s25, s24, 9
    s_add_u32 s25, s25, 0x1940000
    v_lshlrev_b32 v12, 5, v2
    v_lshl_add_u32 v12, v3, 4, v12
    s_setprio 1
    s_waitcnt vmcnt(1)
    s_barrier
    ds_read_b128 v[124:127], v17 offset:0
    ds_read_b64_tr_b16 v[88:89], v8 offset:0
    ds_read_b64_tr_b16 v[90:91], v8 offset:768
    ds_read_b64_tr_b16 v[92:93], v8 offset:64
    ds_read_b64_tr_b16 v[94:95], v8 offset:832
    ds_read_b64_tr_b16 v[96:97], v8 offset:128
    ds_read_b64_tr_b16 v[98:99], v8 offset:896
    ds_read_b128 v[128:131], v18 offset:0
    ds_read_b64_tr_b16 v[100:101], v8 offset:3072
    ds_read_b64_tr_b16 v[102:103], v8 offset:3840
    ds_read_b64_tr_b16 v[104:105], v8 offset:3136
    ds_read_b64_tr_b16 v[106:107], v8 offset:3904
    ds_read_b64_tr_b16 v[108:109], v8 offset:3200
    ds_read_b64_tr_b16 v[110:111], v8 offset:3968
    s_waitcnt lgkmcnt(7)
    v_mfma_f32_32x32x16_bf16 v[40:55], v[88:91], v[124:127], 0
    ds_read_b128 v[132:135], v19 offset:0
    ds_read_b64_tr_b16 v[112:113], v8 offset:6144
    ds_read_b64_tr_b16 v[114:115], v8 offset:6912
    v_mfma_f32_32x32x16_bf16 v[56:71], v[92:95], v[124:127], 0
    ds_read_b64_tr_b16 v[116:117], v8 offset:6208
    ds_read_b64_tr_b16 v[118:119], v8 offset:6976
    v_mfma_f32_32x32x16_bf16 v[72:87], v[96:99], v[124:127], 0
    ds_read_b64_tr_b16 v[120:121], v8 offset:6272
    ds_read_b64_tr_b16 v[122:123], v8 offset:7040
    s_waitcnt lgkmcnt(7)
    v_mfma_f32_32x32x16_bf16 v[40:55], v[100:103], v[128:131], v[40:55]
    ds_read_b128 v[124:127], v20 offset:0
    ds_read_b64_tr_b16 v[88:89], v8 offset:9216
    ds_read_b64_tr_b16 v[90:91], v8 offset:9984
    v_mfma_f32_32x32x16_bf16 v[56:71], v[104:107], v[128:131], v[56:71]
    ds_read_b64_tr_b16 v[92:93], v8 offset:9280
    ds_read_b64_tr_b16 v[94:95], v8 offset:10048
    v_mfma_f32_32x32x16_bf16 v[72:87], v[108:111], v[128:131], v[72:87]
    ds_read_b64_tr_b16 v[96:97], v8 offset:9344
    ds_read_b64_tr_b16 v[98:99], v8 offset:10112
    s_waitcnt vmcnt(8)
    s_barrier
    s_waitcnt lgkmcnt(7)
    v_mfma_f32_32x32x16_bf16 v[40:55], v[112:115], v[132:135], v[40:55]
    ds_read_b128 v[128:131], v17 offset:4096
    ds_read_b64_tr_b16 v[100:101], v8 offset:12288
    ds_read_b64_tr_b16 v[102:103], v8 offset:13056
    v_mfma_f32_32x32x16_bf16 v[56:71], v[116:119], v[132:135], v[56:71]
    ds_read_b64_tr_b16 v[104:105], v8 offset:12352
    ds_read_b64_tr_b16 v[106:107], v8 offset:13120
    v_mfma_f32_32x32x16_bf16 v[72:87], v[120:123], v[132:135], v[72:87]
    ds_read_b64_tr_b16 v[108:109], v8 offset:12416
    ds_read_b64_tr_b16 v[110:111], v8 offset:13184
    s_waitcnt lgkmcnt(7)
    v_mfma_f32_32x32x16_bf16 v[40:55], v[88:91], v[124:127], v[40:55]
    ds_read_b128 v[132:135], v18 offset:4096
    ds_read_b64_tr_b16 v[112:113], v8 offset:15360
    ds_read_b64_tr_b16 v[114:115], v8 offset:16128
    v_mfma_f32_32x32x16_bf16 v[56:71], v[92:95], v[124:127], v[56:71]
    ds_read_b64_tr_b16 v[116:117], v8 offset:15424
    ds_read_b64_tr_b16 v[118:119], v8 offset:16192
    v_mfma_f32_32x32x16_bf16 v[72:87], v[96:99], v[124:127], v[72:87]
    ds_read_b64_tr_b16 v[120:121], v8 offset:15488
    ds_read_b64_tr_b16 v[122:123], v8 offset:16256
    s_waitcnt lgkmcnt(7)
    v_mfma_f32_32x32x16_bf16 v[40:55], v[100:103], v[128:131], v[40:55]
    ds_read_b128 v[124:127], v19 offset:4096
    ds_read_b64_tr_b16 v[88:89], v8 offset:18432
    ds_read_b64_tr_b16 v[90:91], v8 offset:19200
    v_mfma_f32_32x32x16_bf16 v[56:71], v[104:107], v[128:131], v[56:71]
    ds_read_b64_tr_b16 v[92:93], v8 offset:18496
    ds_read_b64_tr_b16 v[94:95], v8 offset:19264
    v_mfma_f32_32x32x16_bf16 v[72:87], v[108:111], v[128:131], v[72:87]
    ds_read_b64_tr_b16 v[96:97], v8 offset:18560
    ds_read_b64_tr_b16 v[98:99], v8 offset:19328
    s_waitcnt lgkmcnt(7)
    v_mfma_f32_32x32x16_bf16 v[40:55], v[112:115], v[132:135], v[40:55]
    ds_read_b128 v[128:131], v20 offset:4096
    ds_read_b64_tr_b16 v[100:101], v8 offset:21504
    ds_read_b64_tr_b16 v[102:103], v8 offset:22272
    v_mfma_f32_32x32x16_bf16 v[56:71], v[116:119], v[132:135], v[56:71]
    ds_read_b64_tr_b16 v[104:105], v8 offset:21568
    ds_read_b64_tr_b16 v[106:107], v8 offset:22336
    v_mfma_f32_32x32x16_bf16 v[72:87], v[120:123], v[132:135], v[72:87]
    ds_read_b64_tr_b16 v[108:109], v8 offset:21632
    ds_read_b64_tr_b16 v[110:111], v8 offset:22400
    s_waitcnt vmcnt(8)
    s_barrier
    s_waitcnt lgkmcnt(7)
    v_mfma_f32_32x32x16_bf16 v[40:55], v[88:91], v[124:127], v[40:55]
    ds_read_b128 v[132:135], v17 offset:8192
    ds_read_b64_tr_b16 v[112:113], v8 offset:24576
    ds_read_b64_tr_b16 v[114:115], v8 offset:25344
    v_mfma_f32_32x32x16_bf16 v[56:71], v[92:95], v[124:127], v[56:71]
    ds_read_b64_tr_b16 v[116:117], v8 offset:24640
    ds_read_b64_tr_b16 v[118:119], v8 offset:25408
    v_mfma_f32_32x32x16_bf16 v[72:87], v[96:99], v[124:127], v[72:87]
    ds_read_b64_tr_b16 v[120:121], v8 offset:24704
    ds_read_b64_tr_b16 v[122:123], v8 offset:25472
    s_waitcnt lgkmcnt(7)
    v_mfma_f32_32x32x16_bf16 v[40:55], v[100:103], v[128:131], v[40:55]
    ds_read_b128 v[124:127], v18 offset:8192
    ds_read_b64_tr_b16 v[88:89], v8 offset:27648
    ds_read_b64_tr_b16 v[90:91], v8 offset:28416
    v_mfma_f32_32x32x16_bf16 v[56:71], v[104:107], v[128:131], v[56:71]
    ds_read_b64_tr_b16 v[92:93], v8 offset:27712
    ds_read_b64_tr_b16 v[94:95], v8 offset:28480
    v_mfma_f32_32x32x16_bf16 v[72:87], v[108:111], v[128:131], v[72:87]
    ds_read_b64_tr_b16 v[96:97], v8 offset:27776
    ds_read_b64_tr_b16 v[98:99], v8 offset:28544
    s_waitcnt lgkmcnt(7)
    v_mfma_f32_32x32x16_bf16 v[40:55], v[112:115], v[132:135], v[40:55]
    ds_read_b128 v[128:131], v19 offset:8192
    ds_read_b64_tr_b16 v[100:101], v8 offset:30720
    ds_read_b64_tr_b16 v[102:103], v8 offset:31488
    v_mfma_f32_32x32x16_bf16 v[56:71], v[116:119], v[132:135], v[56:71]
    ds_read_b64_tr_b16 v[104:105], v8 offset:30784
    ds_read_b64_tr_b16 v[106:107], v8 offset:31552
    v_mfma_f32_32x32x16_bf16 v[72:87], v[120:123], v[132:135], v[72:87]
    ds_read_b64_tr_b16 v[108:109], v8 offset:30848
    ds_read_b64_tr_b16 v[110:111], v8 offset:31616
    s_waitcnt lgkmcnt(7)
    v_mfma_f32_32x32x16_bf16 v[40:55], v[88:91], v[124:127], v[40:55]
    ds_read_b128 v[132:135], v20 offset:8192
    ds_read_b64_tr_b16 v[112:113], v8 offset:33792
    ds_read_b64_tr_b16 v[114:115], v8 offset:34560
    v_mfma_f32_32x32x16_bf16 v[56:71], v[92:95], v[124:127], v[56:71]
    ds_read_b64_tr_b16 v[116:117], v8 offset:33856
    ds_read_b64_tr_b16 v[118:119], v8 offset:34624
    v_mfma_f32_32x32x16_bf16 v[72:87], v[96:99], v[124:127], v[72:87]
    ds_read_b64_tr_b16 v[120:121], v8 offset:33920
    ds_read_b64_tr_b16 v[122:123], v8 offset:34688
    s_waitcnt vmcnt(8)
    s_barrier
    s_waitcnt lgkmcnt(7)
    v_mfma_f32_32x32x16_bf16 v[40:55], v[100:103], v[128:131], v[40:55]
    ds_read_b128 v[124:127], v17 offset:12288
    ds_read_b64_tr_b16 v[88:89], v8 offset:36864
    ds_read_b64_tr_b16 v[90:91], v8 offset:37632
    v_mfma_f32_32x32x16_bf16 v[56:71], v[104:107], v[128:131], v[56:71]
    ds_read_b64_tr_b16 v[92:93], v8 offset:36928
    ds_read_b64_tr_b16 v[94:95], v8 offset:37696
    v_mfma_f32_32x32x16_bf16 v[72:87], v[108:111], v[128:131], v[72:87]
    ds_read_b64_tr_b16 v[96:97], v8 offset:36992
    ds_read_b64_tr_b16 v[98:99], v8 offset:37760
    s_waitcnt lgkmcnt(7)
    v_mfma_f32_32x32x16_bf16 v[40:55], v[112:115], v[132:135], v[40:55]
    ds_read_b128 v[128:131], v18 offset:12288
    ds_read_b64_tr_b16 v[100:101], v8 offset:39936
    ds_read_b64_tr_b16 v[102:103], v8 offset:40704
    v_mfma_f32_32x32x16_bf16 v[56:71], v[116:119], v[132:135], v[56:71]
    ds_read_b64_tr_b16 v[104:105], v8 offset:40000
    ds_read_b64_tr_b16 v[106:107], v8 offset:40768
    v_mfma_f32_32x32x16_bf16 v[72:87], v[120:123], v[132:135], v[72:87]
    ds_read_b64_tr_b16 v[108:109], v8 offset:40064
    ds_read_b64_tr_b16 v[110:111], v8 offset:40832
    s_waitcnt lgkmcnt(7)
    v_mfma_f32_32x32x16_bf16 v[40:55], v[88:91], v[124:127], v[40:55]
    ds_read_b128 v[132:135], v19 offset:12288
    ds_read_b64_tr_b16 v[112:113], v8 offset:43008
    ds_read_b64_tr_b16 v[114:115], v8 offset:43776
    v_mfma_f32_32x32x16_bf16 v[56:71], v[92:95], v[124:127], v[56:71]
    ds_read_b64_tr_b16 v[116:117], v8 offset:43072
    ds_read_b64_tr_b16 v[118:119], v8 offset:43840
    v_mfma_f32_32x32x16_bf16 v[72:87], v[96:99], v[124:127], v[72:87]
    ds_read_b64_tr_b16 v[120:121], v8 offset:43136
    ds_read_b64_tr_b16 v[122:123], v8 offset:43904
    s_waitcnt lgkmcnt(7)
    v_mfma_f32_32x32x16_bf16 v[40:55], v[100:103], v[128:131], v[40:55]
    ds_read_b128 v[124:127], v20 offset:12288
    ds_read_b64_tr_b16 v[88:89], v8 offset:46080
    ds_read_b64_tr_b16 v[90:91], v8 offset:46848
    v_mfma_f32_32x32x16_bf16 v[56:71], v[104:107], v[128:131], v[56:71]
    ds_read_b64_tr_b16 v[92:93], v8 offset:46144
    ds_read_b64_tr_b16 v[94:95], v8 offset:46912
    v_mfma_f32_32x32x16_bf16 v[72:87], v[108:111], v[128:131], v[72:87]
    ds_read_b64_tr_b16 v[96:97], v8 offset:46208
    ds_read_b64_tr_b16 v[98:99], v8 offset:46976
    s_waitcnt vmcnt(8)
    s_barrier
    s_waitcnt lgkmcnt(7)
    v_mfma_f32_32x32x16_bf16 v[40:55], v[112:115], v[132:135], v[40:55]
    ds_read_b128 v[128:131], v17 offset:16384
    ds_read_b64_tr_b16 v[100:101], v8 offset:49152
    ds_read_b64_tr_b16 v[102:103], v8 offset:49920
    v_mfma_f32_32x32x16_bf16 v[56:71], v[116:119], v[132:135], v[56:71]
    ds_read_b64_tr_b16 v[104:105], v8 offset:49216
    ds_read_b64_tr_b16 v[106:107], v8 offset:49984
    v_mfma_f32_32x32x16_bf16 v[72:87], v[120:123], v[132:135], v[72:87]
    ds_read_b64_tr_b16 v[108:109], v8 offset:49280
    ds_read_b64_tr_b16 v[110:111], v8 offset:50048
    s_waitcnt lgkmcnt(7)
    v_mfma_f32_32x32x16_bf16 v[40:55], v[88:91], v[124:127], v[40:55]
    ds_read_b128 v[132:135], v18 offset:16384
    ds_read_b64_tr_b16 v[112:113], v8 offset:52224
    ds_read_b64_tr_b16 v[114:115], v8 offset:52992
    v_mfma_f32_32x32x16_bf16 v[56:71], v[92:95], v[124:127], v[56:71]
    ds_read_b64_tr_b16 v[116:117], v8 offset:52288
    ds_read_b64_tr_b16 v[118:119], v8 offset:53056
    v_mfma_f32_32x32x16_bf16 v[72:87], v[96:99], v[124:127], v[72:87]
    ds_read_b64_tr_b16 v[120:121], v8 offset:52352
    ds_read_b64_tr_b16 v[122:123], v8 offset:53120
    s_waitcnt lgkmcnt(7)
    v_mfma_f32_32x32x16_bf16 v[40:55], v[100:103], v[128:131], v[40:55]
    ds_read_b128 v[124:127], v19 offset:16384
    ds_read_b64_tr_b16 v[88:89], v8 offset:55296
    ds_read_b64_tr_b16 v[90:91], v8 offset:56064
    v_mfma_f32_32x32x16_bf16 v[56:71], v[104:107], v[128:131], v[56:71]
    ds_read_b64_tr_b16 v[92:93], v8 offset:55360
    ds_read_b64_tr_b16 v[94:95], v8 offset:56128
    v_mfma_f32_32x32x16_bf16 v[72:87], v[108:111], v[128:131], v[72:87]
    ds_read_b64_tr_b16 v[96:97], v8 offset:55424
    ds_read_b64_tr_b16 v[98:99], v8 offset:56192
    s_waitcnt lgkmcnt(7)
    v_mfma_f32_32x32x16_bf16 v[40:55], v[112:115], v[132:135], v[40:55]
    ds_read_b128 v[128:131], v20 offset:16384
    ds_read_b64_tr_b16 v[100:101], v8 offset:58368
    ds_read_b64_tr_b16 v[102:103], v8 offset:59136
    v_mfma_f32_32x32x16_bf16 v[56:71], v[116:119], v[132:135], v[56:71]
    ds_read_b64_tr_b16 v[104:105], v8 offset:58432
    ds_read_b64_tr_b16 v[106:107], v8 offset:59200
    v_mfma_f32_32x32x16_bf16 v[72:87], v[120:123], v[132:135], v[72:87]
    ds_read_b64_tr_b16 v[108:109], v8 offset:58496
    ds_read_b64_tr_b16 v[110:111], v8 offset:59264
    s_waitcnt vmcnt(8)
    s_barrier
    s_waitcnt lgkmcnt(7)
    v_mfma_f32_32x32x16_bf16 v[40:55], v[88:91], v[124:127], v[40:55]
    ds_read_b128 v[132:135], v17 offset:0
    ds_read_b64_tr_b16 v[112:113], v8 offset:0
    ds_read_b64_tr_b16 v[114:115], v8 offset:768
    v_mfma_f32_32x32x16_bf16 v[56:71], v[92:95], v[124:127], v[56:71]
    ds_read_b64_tr_b16 v[116:117], v8 offset:64
    ds_read_b64_tr_b16 v[118:119], v8 offset:832
    v_mfma_f32_32x32x16_bf16 v[72:87], v[96:99], v[124:127], v[72:87]
    ds_read_b64_tr_b16 v[120:121], v8 offset:128
    ds_read_b64_tr_b16 v[122:123], v8 offset:896
    s_waitcnt lgkmcnt(7)
    v_mfma_f32_32x32x16_bf16 v[40:55], v[100:103], v[128:131], v[40:55]
    ds_read_b128 v[124:127], v18 offset:0
    ds_read_b64_tr_b16 v[88:89], v8 offset:3072
    ds_read_b64_tr_b16 v[90:91], v8 offset:3840
    v_mfma_f32_32x32x16_bf16 v[56:71], v[104:107], v[128:131], v[56:71]
    ds_read_b64_tr_b16 v[92:93], v8 offset:3136
    ds_read_b64_tr_b16 v[94:95], v8 offset:3904
    v_mfma_f32_32x32x16_bf16 v[72:87], v[108:111], v[128:131], v[72:87]
    ds_read_b64_tr_b16 v[96:97], v8 offset:3200
    ds_read_b64_tr_b16 v[98:99], v8 offset:3968
    s_lshl_b32 s5, s3, 1
    s_lshr_b32 s6, s4, 4
    s_add_u32 s5, s5, s6
    s_lshl_b32 s5, s5, 1
    s_and_b32 s6, s4, 1
    s_add_u32 s5, s5, s6
    s_lshl_b32 s5, s5, 1
    s_and_b32 s6, s33, 1
    s_add_u32 s5, s5, s6
    s_lshl_b32 s5, s5, 15
    s_and_b32 s6, s4, 14
    s_lshr_b32 s7, s33, 1
    s_add_u32 s6, s6, s7
    s_lshl_b32 s6, s6, 6
    s_add_u32 s28, s5, s6
    v_lshlrev_b32 v5, 10, v2
    v_lshl_add_u32 v5, v3, 3, v5
    s_waitcnt lgkmcnt(7)
    v_mfma_f32_32x32x16_bf16 v[40:55], v[112:115], v[132:135], v[40:55]
    ds_read_b128 v[128:131], v19 offset:0
    ds_read_b64_tr_b16 v[100:101], v8 offset:6144
    ds_read_b64_tr_b16 v[102:103], v8 offset:6912
    v_mfma_f32_32x32x16_bf16 v[56:71], v[116:119], v[132:135], v[56:71]
    ds_read_b64_tr_b16 v[104:105], v8 offset:6208
    ds_read_b64_tr_b16 v[106:107], v8 offset:6976
    v_mfma_f32_32x32x16_bf16 v[72:87], v[120:123], v[132:135], v[72:87]
    ds_read_b64_tr_b16 v[108:109], v8 offset:6272
    ds_read_b64_tr_b16 v[110:111], v8 offset:7040
    s_waitcnt lgkmcnt(7)
    v_mfma_f32_32x32x16_bf16 v[40:55], v[88:91], v[124:127], v[40:55]
    ds_read_b128 v[132:135], v20 offset:0
    ds_read_b64_tr_b16 v[112:113], v8 offset:9216
    ds_read_b64_tr_b16 v[114:115], v8 offset:9984
    v_mfma_f32_32x32x16_bf16 v[56:71], v[92:95], v[124:127], v[56:71]
    ds_read_b64_tr_b16 v[116:117], v8 offset:9280
    ds_read_b64_tr_b16 v[118:119], v8 offset:10048
    v_mfma_f32_32x32x16_bf16 v[72:87], v[96:99], v[124:127], v[72:87]
    ds_read_b64_tr_b16 v[120:121], v8 offset:9344
    ds_read_b64_tr_b16 v[122:123], v8 offset:10112
    s_waitcnt vmcnt(8)
    s_barrier
    s_waitcnt lgkmcnt(7)
    v_mfma_f32_32x32x16_bf16 v[40:55], v[100:103], v[128:131], v[40:55]
    ds_read_b128 v[124:127], v17 offset:4096
    ds_read_b64_tr_b16 v[88:89], v8 offset:12288
    ds_read_b64_tr_b16 v[90:91], v8 offset:13056
    v_mfma_f32_32x32x16_bf16 v[56:71], v[104:107], v[128:131], v[56:71]
    ds_read_b64_tr_b16 v[92:93], v8 offset:12352
    ds_read_b64_tr_b16 v[94:95], v8 offset:13120
    v_mfma_f32_32x32x16_bf16 v[72:87], v[108:111], v[128:131], v[72:87]
    ds_read_b64_tr_b16 v[96:97], v8 offset:12416
    ds_read_b64_tr_b16 v[98:99], v8 offset:13184
    s_waitcnt lgkmcnt(7)
    v_mfma_f32_32x32x16_bf16 v[40:55], v[112:115], v[132:135], v[40:55]
    ds_read_b128 v[128:131], v18 offset:4096
    ds_read_b64_tr_b16 v[100:101], v8 offset:15360
    ds_read_b64_tr_b16 v[102:103], v8 offset:16128
    v_mfma_f32_32x32x16_bf16 v[56:71], v[116:119], v[132:135], v[56:71]
    ds_read_b64_tr_b16 v[104:105], v8 offset:15424
    ds_read_b64_tr_b16 v[106:107], v8 offset:16192
    v_mfma_f32_32x32x16_bf16 v[72:87], v[120:123], v[132:135], v[72:87]
    ds_read_b64_tr_b16 v[108:109], v8 offset:15488
    ds_read_b64_tr_b16 v[110:111], v8 offset:16256
    buffer_load_dwordx4 v[36:39], v10, s[12:15], s25 offen sc1
    s_waitcnt lgkmcnt(7)
    v_mfma_f32_32x32x16_bf16 v[40:55], v[88:91], v[124:127], v[40:55]
    ds_read_b128 v[132:135], v19 offset:4096
    ds_read_b64_tr_b16 v[112:113], v8 offset:18432
    ds_read_b64_tr_b16 v[114:115], v8 offset:19200
    v_mfma_f32_32x32x16_bf16 v[56:71], v[92:95], v[124:127], v[56:71]
    ds_read_b64_tr_b16 v[116:117], v8 offset:18496
    ds_read_b64_tr_b16 v[118:119], v8 offset:19264
    buffer_load_dwordx2 v[24:25], v5, s[8:11], s28 offen offset:0
    v_mfma_f32_32x32x16_bf16 v[72:87], v[96:99], v[124:127], v[72:87]
    ds_read_b64_tr_b16 v[120:121], v8 offset:18560
    ds_read_b64_tr_b16 v[122:123], v8 offset:19328
    s_waitcnt lgkmcnt(7)
    v_mfma_f32_32x32x16_bf16 v[40:55], v[100:103], v[128:131], v[40:55]
    ds_read_b128 v[124:127], v20 offset:4096
    ds_read_b64_tr_b16 v[88:89], v8 offset:21504
    ds_read_b64_tr_b16 v[90:91], v8 offset:22272
    v_mfma_f32_32x32x16_bf16 v[56:71], v[104:107], v[128:131], v[56:71]
    ds_read_b64_tr_b16 v[92:93], v8 offset:21568
    ds_read_b64_tr_b16 v[94:95], v8 offset:22336
    buffer_load_dwordx2 v[26:27], v5, s[8:11], s28 offen offset:16
    v_mfma_f32_32x32x16_bf16 v[72:87], v[108:111], v[128:131], v[72:87]
    ds_read_b64_tr_b16 v[96:97], v8 offset:21632
    ds_read_b64_tr_b16 v[98:99], v8 offset:22400
    s_waitcnt vmcnt(11)
    s_barrier
    s_waitcnt lgkmcnt(7)
    v_mfma_f32_32x32x16_bf16 v[40:55], v[112:115], v[132:135], v[40:55]
    ds_read_b128 v[128:131], v17 offset:8192
    ds_read_b64_tr_b16 v[100:101], v8 offset:24576
    ds_read_b64_tr_b16 v[102:103], v8 offset:25344
    v_mfma_f32_32x32x16_bf16 v[56:71], v[116:119], v[132:135], v[56:71]
    ds_read_b64_tr_b16 v[104:105], v8 offset:24640
    ds_read_b64_tr_b16 v[106:107], v8 offset:25408
    buffer_load_dwordx2 v[28:29], v5, s[8:11], s28 offen offset:32
    v_mfma_f32_32x32x16_bf16 v[72:87], v[120:123], v[132:135], v[72:87]
    ds_read_b64_tr_b16 v[108:109], v8 offset:24704
    ds_read_b64_tr_b16 v[110:111], v8 offset:25472
    s_waitcnt lgkmcnt(7)
    v_mfma_f32_32x32x16_bf16 v[40:55], v[88:91], v[124:127], v[40:55]
    ds_read_b128 v[132:135], v18 offset:8192
    ds_read_b64_tr_b16 v[112:113], v8 offset:27648
    ds_read_b64_tr_b16 v[114:115], v8 offset:28416
    v_mfma_f32_32x32x16_bf16 v[56:71], v[92:95], v[124:127], v[56:71]
    ds_read_b64_tr_b16 v[116:117], v8 offset:27712
    ds_read_b64_tr_b16 v[118:119], v8 offset:28480
    buffer_load_dwordx2 v[30:31], v5, s[8:11], s28 offen offset:48
    v_mfma_f32_32x32x16_bf16 v[72:87], v[96:99], v[124:127], v[72:87]
    ds_read_b64_tr_b16 v[120:121], v8 offset:27776
    ds_read_b64_tr_b16 v[122:123], v8 offset:28544
    s_waitcnt lgkmcnt(7)
    v_mfma_f32_32x32x16_bf16 v[40:55], v[100:103], v[128:131], v[40:55]
    ds_read_b128 v[124:127], v19 offset:8192
    ds_read_b64_tr_b16 v[88:89], v8 offset:30720
    ds_read_b64_tr_b16 v[90:91], v8 offset:31488
    v_mfma_f32_32x32x16_bf16 v[56:71], v[104:107], v[128:131], v[56:71]
    ds_read_b64_tr_b16 v[92:93], v8 offset:30784
    ds_read_b64_tr_b16 v[94:95], v8 offset:31552
    s_mul_i32 s6, s31, 3
    s_lshl_b32 s7, s24, 10
    s_add_u32 s7, s7, 0x200000
    v_mov_b32 v6, 143808
    v_mfma_f32_32x32x16_bf16 v[72:87], v[108:111], v[128:131], v[72:87]
    ds_read_b64_tr_b16 v[96:97], v8 offset:30848
    ds_read_b64_tr_b16 v[98:99], v8 offset:31616
    s_waitcnt lgkmcnt(7)
    v_mfma_f32_32x32x16_bf16 v[40:55], v[112:115], v[132:135], v[40:55]
    ds_read_b128 v[128:131], v20 offset:8192
    ds_read_b64_tr_b16 v[100:101], v8 offset:33792
    ds_read_b64_tr_b16 v[102:103], v8 offset:34560
    v_mfma_f32_32x32x16_bf16 v[56:71], v[116:119], v[132:135], v[56:71]
    ds_read_b64_tr_b16 v[104:105], v8 offset:33856
    ds_read_b64_tr_b16 v[106:107], v8 offset:34624
    v_mfma_f32_32x32x16_bf16 v[72:87], v[120:123], v[132:135], v[72:87]
    ds_read_b64_tr_b16 v[108:109], v8 offset:33920
    ds_read_b64_tr_b16 v[110:111], v8 offset:34688
    s_barrier
    s_waitcnt lgkmcnt(7)
    v_mfma_f32_32x32x16_bf16 v[40:55], v[88:91], v[124:127], v[40:55]
    ds_read_b32 v6, v6
    ds_read_b128 v[136:139], v9 offset:0
    ds_read_b128 v[140:143], v9 offset:32
    v_mfma_f32_32x32x16_bf16 v[56:71], v[92:95], v[124:127], v[56:71]
    ds_read_b128 v[144:147], v9 offset:64
    ds_read_b128 v[148:151], v9 offset:96
    v_mfma_f32_32x32x16_bf16 v[72:87], v[96:99], v[124:127], v[72:87]
    ds_read_b128 v[152:155], v9 offset:128
    ds_read_b128 v[156:159], v9 offset:160
    s_waitcnt lgkmcnt(7)
    v_mfma_f32_32x32x16_bf16 v[40:55], v[100:103], v[128:131], v[40:55]
    ds_read_b128 v[160:163], v9 offset:192
    ds_read_b128 v[164:167], v9 offset:224
    v_mfma_f32_32x32x16_bf16 v[56:71], v[104:107], v[128:131], v[56:71]
    ds_read_b128 v[168:171], v9 offset:256
    ds_read_b128 v[172:175], v9 offset:288
    v_mfma_f32_32x32x16_bf16 v[72:87], v[108:111], v[128:131], v[72:87]
    ds_read_b128 v[176:179], v9 offset:320
    ds_read_b128 v[180:183], v9 offset:352
    s_mov_b32 s5, 0
    s_waitcnt vmcnt(4) lgkmcnt(12)
stp_2:
    v_cmp_ne_u32 vcc, v6, v38
    s_cbranch_vccz std_3
    buffer_load_dwordx4 v[36:39], v10, s[12:15], s25 offen sc1
    s_add_u32 s5, s5, 1
    s_cmp_lt_u32 s5, 262144
    s_waitcnt vmcnt(0)
    s_cbranch_scc1 stp_2
std_3:
    s_add_u32 s5, s6, 0
    s_lshl_b32 s20, s5, 17
    s_add_u32 s20, s20, s7
    s_add_u32 s21, s20, 65536
    s_cmp_lt_u32 s5, 16
    s_cselect_b32 s22, 0x3eb8aa3b, 1.0
    s_cmp_lt_u32 s5, 32
    s_cselect_b64 vcc, -1, 0
    v_cndmask_b32 v11, v12, v7, vcc
    v_mul_f32 v32, s22, v37
    s_waitcnt lgkmcnt(8)
.p2align 3
    v_pk_fma_f32 v[40:41], v[136:137], v[36:37], v[40:41] op_sel_hi:[1,0,1]
    v_pk_fma_f32 v[42:43], v[138:139], v[36:37], v[42:43] op_sel_hi:[1,0,1]
    v_pk_fma_f32 v[44:45], v[140:141], v[36:37], v[44:45] op_sel_hi:[1,0,1]
    v_pk_fma_f32 v[46:47], v[142:143], v[36:37], v[46:47] op_sel_hi:[1,0,1]
    v_pk_fma_f32 v[48:49], v[144:145], v[36:37], v[48:49] op_sel_hi:[1,0,1]
    v_pk_fma_f32 v[50:51], v[146:147], v[36:37], v[50:51] op_sel_hi:[1,0,1]
    v_pk_fma_f32 v[52:53], v[148:149], v[36:37], v[52:53] op_sel_hi:[1,0,1]
    v_pk_fma_f32 v[54:55], v[150:151], v[36:37], v[54:55] op_sel_hi:[1,0,1]
    v_pk_mul_f32 v[40:41], v[40:41], v[32:33] op_sel_hi:[1,0]
    v_pk_mul_f32 v[42:43], v[42:43], v[32:33] op_sel_hi:[1,0]
    v_pk_mul_f32 v[44:45], v[44:45], v[32:33] op_sel_hi:[1,0]
    v_pk_mul_f32 v[46:47], v[46:47], v[32:33] op_sel_hi:[1,0]
    v_pk_mul_f32 v[48:49], v[48:49], v[32:33] op_sel_hi:[1,0]
    v_pk_mul_f32 v[50:51], v[50:51], v[32:33] op_sel_hi:[1,0]
    v_pk_mul_f32 v[52:53], v[52:53], v[32:33] op_sel_hi:[1,0]
    v_pk_mul_f32 v[54:55], v[54:55], v[32:33] op_sel_hi:[1,0]
    v_cvt_pk_bf16_f32 v88, v40, v41
    v_cvt_pk_bf16_f32 v89, v42, v43
    v_cvt_pk_bf16_f32 v90, v44, v45
    v_cvt_pk_bf16_f32 v91, v46, v47
    v_cvt_pk_bf16_f32 v92, v48, v49
    v_cvt_pk_bf16_f32 v93, v50, v51
    v_cvt_pk_bf16_f32 v94, v52, v53
    v_cvt_pk_bf16_f32 v95, v54, v55
    buffer_store_dwordx4 v[88:91], v11, s[12:15], s20 offen sc1
    buffer_store_dwordx4 v[92:95], v11, s[12:15], s21 offen sc1
    s_add_u32 s5, s6, 1
    s_lshl_b32 s20, s5, 17
    s_add_u32 s20, s20, s7
    s_add_u32 s21, s20, 65536
    s_cmp_lt_u32 s5, 16
    s_cselect_b32 s22, 0x3eb8aa3b, 1.0
    s_cmp_lt_u32 s5, 32
    s_cselect_b64 vcc, -1, 0
    v_cndmask_b32 v11, v12, v7, vcc
    v_mul_f32 v32, s22, v37
    s_waitcnt lgkmcnt(4)
.p2align 3
    v_pk_fma_f32 v[56:57], v[152:153], v[36:37], v[56:57] op_sel_hi:[1,0,1]
    v_pk_fma_f32 v[58:59], v[154:155], v[36:37], v[58:59] op_sel_hi:[1,0,1]
    v_pk_fma_f32 v[60:61], v[156:157], v[36:37], v[60:61] op_sel_hi:[1,0,1]
    v_pk_fma_f32 v[62:63], v[158:159], v[36:37], v[62:63] op_sel_hi:[1,0,1]
    v_pk_fma_f32 v[64:65], v[160:161], v[36:37], v[64:65] op_sel_hi:[1,0,1]
    v_pk_fma_f32 v[66:67], v[162:163], v[36:37], v[66:67] op_sel_hi:[1,0,1]
    v_pk_fma_f32 v[68:69], v[164:165], v[36:37], v[68:69] op_sel_hi:[1,0,1]
    v_pk_fma_f32 v[70:71], v[166:167], v[36:37], v[70:71] op_sel_hi:[1,0,1]
    v_pk_mul_f32 v[56:57], v[56:57], v[32:33] op_sel_hi:[1,0]
    v_pk_mul_f32 v[58:59], v[58:59], v[32:33] op_sel_hi:[1,0]
    v_pk_mul_f32 v[60:61], v[60:61], v[32:33] op_sel_hi:[1,0]
    v_pk_mul_f32 v[62:63], v[62:63], v[32:33] op_sel_hi:[1,0]
    v_pk_mul_f32 v[64:65], v[64:65], v[32:33] op_sel_hi:[1,0]
    v_pk_mul_f32 v[66:67], v[66:67], v[32:33] op_sel_hi:[1,0]
    v_pk_mul_f32 v[68:69], v[68:69], v[32:33] op_sel_hi:[1,0]
    v_pk_mul_f32 v[70:71], v[70:71], v[32:33] op_sel_hi:[1,0]
    v_cvt_pk_bf16_f32 v96, v56, v57
    v_cvt_pk_bf16_f32 v97, v58, v59
    v_cvt_pk_bf16_f32 v98, v60, v61
    v_cvt_pk_bf16_f32 v99, v62, v63
    v_cvt_pk_bf16_f32 v100, v64, v65
    v_cvt_pk_bf16_f32 v101, v66, v67
    v_cvt_pk_bf16_f32 v102, v68, v69
    v_cvt_pk_bf16_f32 v103, v70, v71
    buffer_store_dwordx4 v[96:99], v11, s[12:15], s20 offen sc1
    buffer_store_dwordx4 v[100:103], v11, s[12:15], s21 offen sc1
    s_add_u32 s5, s6, 2
    s_lshl_b32 s20, s5, 17
    s_add_u32 s20, s20, s7
    s_add_u32 s21, s20, 65536
    s_cmp_lt_u32 s5, 16
    s_cselect_b32 s22, 0x3eb8aa3b, 1.0
    s_cmp_lt_u32 s5, 32
    s_cselect_b64 vcc, -1, 0
    v_cndmask_b32 v11, v12, v7, vcc
    v_mul_f32 v32, s22, v37
    s_waitcnt lgkmcnt(0)
.p2align 3
    v_pk_fma_f32 v[72:73], v[168:169], v[36:37], v[72:73] op_sel_hi:[1,0,1]
    v_pk_fma_f32 v[74:75], v[170:171], v[36:37], v[74:75] op_sel_hi:[1,0,1]
    v_pk_fma_f32 v[76:77], v[172:173], v[36:37], v[76:77] op_sel_hi:[1,0,1]
    v_pk_fma_f32 v[78:79], v[174:175], v[36:37], v[78:79] op_sel_hi:[1,0,1]
    v_pk_fma_f32 v[80:81], v[176:177], v[36:37], v[80:81] op_sel_hi:[1,0,1]
    v_pk_fma_f32 v[82:83], v[178:179], v[36:37], v[82:83] op_sel_hi:[1,0,1]
    v_pk_fma_f32 v[84:85], v[180:181], v[36:37], v[84:85] op_sel_hi:[1,0,1]
    v_pk_fma_f32 v[86:87], v[182:183], v[36:37], v[86:87] op_sel_hi:[1,0,1]
    v_pk_mul_f32 v[72:73], v[72:73], v[32:33] op_sel_hi:[1,0]
    v_pk_mul_f32 v[74:75], v[74:75], v[32:33] op_sel_hi:[1,0]
    v_pk_mul_f32 v[76:77], v[76:77], v[32:33] op_sel_hi:[1,0]
    v_pk_mul_f32 v[78:79], v[78:79], v[32:33] op_sel_hi:[1,0]
    v_pk_mul_f32 v[80:81], v[80:81], v[32:33] op_sel_hi:[1,0]
    v_pk_mul_f32 v[82:83], v[82:83], v[32:33] op_sel_hi:[1,0]
    v_pk_mul_f32 v[84:85], v[84:85], v[32:33] op_sel_hi:[1,0]
    v_pk_mul_f32 v[86:87], v[86:87], v[32:33] op_sel_hi:[1,0]
    v_cvt_pk_bf16_f32 v104, v72, v73
    v_cvt_pk_bf16_f32 v105, v74, v75
    v_cvt_pk_bf16_f32 v106, v76, v77
    v_cvt_pk_bf16_f32 v107, v78, v79
    v_cvt_pk_bf16_f32 v108, v80, v81
    v_cvt_pk_bf16_f32 v109, v82, v83
    v_cvt_pk_bf16_f32 v110, v84, v85
    v_cvt_pk_bf16_f32 v111, v86, v87
    buffer_store_dwordx4 v[104:107], v11, s[12:15], s20 offen sc1
    buffer_store_dwordx4 v[108:111], v11, s[12:15], s21 offen sc1
    v_readfirstlane_b32 s100, v6
    s_lshl_b32 s59, s24, 4
    s_add_u32 s59, s59, s31
    s_lshl_b32 s59, s59, 7
    s_add_u32 s59, s59, 0x1900000
    s_setprio 0
    s_branch ac_first
k1_helper:
    s_lshl_b32 s26, s30, 4
    s_add_u32 s26, s26, s31
    s_lshl_b32 s26, s26, 2
    s_add_u32 s26, s26, s33
    s_lshl_b32 s27, s26, 11
    s_waitcnt lgkmcnt(0)
    s_mov_b32 s8, s16
    s_mov_b32 s9, s17
    s_mov_b32 s40, s18
    s_mov_b32 s41, s19
    s_mov_b32 s12, s46
    s_mov_b32 s13, s47
    s_mov_b32 s46, 0x100
    s_mov_b32 s47, 0x00020000
    buffer_load_dwordx4 v[136:139], v7, s[8:11], s27 offen offset:0
    buffer_load_dwordx4 v[140:143], v7, s[8:11], s27 offen offset:1024
    v_lshlrev_b32 v4, 7, v1
    s_lshl_b32 s5, s2, 2
    s_add_u32 s5, s5, s33
    s_mul_i32 s5, s5, 1536
    s_mov_b64 exec, 0xfff
    buffer_load_dword v32, v4, s[40:43], s5 offen
    s_mov_b64 exec, -1
    s_xor_b32 s29, s35, 1
    s_add_u32 m0, s37, 12288
    s_mul_i32 s29, s29, 196608
    s_add_u32 s29, s29, s36
    buffer_load_dwordx4 v180, s[40:43], s29 offen offset:0  lds
    buffer_load_dwordx4 v181, s[40:43], s29 offen offset:1024  lds
    buffer_load_dwordx4 v182, s[40:43], s29 offen offset:2048  lds
    s_xor_b32 s29, s35, 2
    s_add_u32 m0, s37, 24576
    s_mul_i32 s29, s29, 196608
    s_add_u32 s29, s29, s36
    buffer_load_dwordx4 v180, s[40:43], s29 offen offset:0  lds
    buffer_load_dwordx4 v181, s[40:43], s29 offen offset:1024  lds
    buffer_load_dwordx4 v182, s[40:43], s29 offen offset:2048  lds
    v_lshrrev_b32 v4, 3, v1
    v_and_b32 v5, 7, v0
    v_lshrrev_b32 v6, 4, v1
    v_xor_b32 v5, v5, v6
    v_lshlrev_b32 v5, 4, v5
    v_lshl_add_u32 v13, v4, 10, v5
    v_xor_b32 v14, 64, v13
    v_add_u32 v14, 7168, v14
    v_add_u32 v15, 14336, v13
    v_add_u32 v16, 14336, v14
    s_lshl_b32 s20, s24, 15
    s_mul_i32 s21, s33, 20480
    v_bfe_u32 v4, v0, 2, 2
    v_lshl_add_u32 v4, v3, 3, v4
    v_mul_u32_u24 v4, 192, v4
    v_bfe_u32 v5, v0, 4, 1
    v_lshl_add_u32 v4, v5, 5, v4
    v_and_b32 v5, 3, v0
    v_lshl_add_u32 v4, v5, 3, v4
    v_add_u32 v8, 81920, v4
    s_min_u32 s25, s33, 2
    s_lshl_b32 s5, s25, 6
    v_add_u32 v8, s5, v8
    s_lshl_b32 s5, s25, 7
    s_add_u32 s5, s5, 143360
    v_lshlrev_b32 v4, 2, v2
    v_add_u32 v9, s5, v4
    v_bfe_u32 v4, v0, 2, 1
    v_bfe_u32 v5, v0, 4, 1
    v_xor_b32 v4, v4, v5
    v_add_u32 v4, -1, v4
    v_and_b32 v144, 0x3f803f80, v4
    v_mov_b32 v148, 0
    v_and_b32 v145, 0x3f803f80, v4
    v_mov_b32 v149, 0
    v_and_b32 v146, 0x3f803f80, v4
    v_mov_b32 v150, 0
    v_and_b32 v147, 0x3f803f80, v4
    v_mov_b32 v151, 0
    v_mov_b32 v152, 0x3f803f80
    v_lshlrev_b32 v10, 4, v3
    s_lshl_b32 s27, s26, 5
    s_add_u32 s27, s27, 0x1940000
    s_waitcnt vmcnt(9)
    s_barrier
    ds_read_b64_tr_b16 v[88:89], v8 offset:0
    ds_read_b64_tr_b16 v[90:91], v8 offset:768
    ds_read_b64_tr_b16 v[92:93], v8 offset:3072
    ds_read_b64_tr_b16 v[94:95], v8 offset:3840
    s_xor_b32 s29, s35, 1
    s_add_u32 m0, s21, 4096
    s_lshl_b32 s29, s29, 7
    s_add_u32 s29, s29, s20
    buffer_load_dwordx4 v13, s[8:11], s29 offen offset:0  lds
    buffer_load_dwordx4 v14, s[8:11], s29 offen offset:1024  lds
    buffer_load_dwordx4 v15, s[8:11], s29 offen offset:2048  lds
    buffer_load_dwordx4 v16, s[8:11], s29 offen offset:3072  lds
    s_xor_b32 s29, s35, 2
    s_add_u32 m0, s21, 8192
    s_lshl_b32 s29, s29, 7
    s_add_u32 s29, s29, s20
    buffer_load_dwordx4 v13, s[8:11], s29 offen offset:0  lds
    buffer_load_dwordx4 v14, s[8:11], s29 offen offset:1024  lds
    buffer_load_dwordx4 v15, s[8:11], s29 offen offset:2048  lds
    buffer_load_dwordx4 v16, s[8:11], s29 offen offset:3072  lds
    s_xor_b32 s29, s35, 3
    s_add_u32 m0, s37, 36864
    s_mul_i32 s29, s29, 196608
    s_add_u32 s29, s29, s36
    buffer_load_dwordx4 v180, s[40:43], s29 offen offset:0  lds
    buffer_load_dwordx4 v181, s[40:43], s29 offen offset:1024  lds
    buffer_load_dwordx4 v182, s[40:43], s29 offen offset:2048  lds
    buffer_load_dword v38, off, s[44:47], 0 sc1
    s_waitcnt vmcnt(19)
    v_dot2_f32_bf16 v148, v136, v152, v148
    v_dot2_f32_bf16 v150, v136, v136, v150
    v_dot2_f32_bf16 v149, v140, v152, v149
    v_dot2_f32_bf16 v151, v140, v140, v151
    v_dot2_f32_bf16 v148, v137, v152, v148
    v_dot2_f32_bf16 v150, v137, v137, v150
    v_dot2_f32_bf16 v149, v141, v152, v149
    v_dot2_f32_bf16 v151, v141, v141, v151
    v_dot2_f32_bf16 v148, v138, v152, v148
    v_dot2_f32_bf16 v150, v138, v138, v150
    v_dot2_f32_bf16 v149, v142, v152, v149
    v_dot2_f32_bf16 v151, v142, v142, v151
    v_dot2_f32_bf16 v148, v139, v152, v148
    v_dot2_f32_bf16 v150, v139, v139, v150
    v_dot2_f32_bf16 v149, v143, v152, v149
    v_dot2_f32_bf16 v151, v143, v143, v151
    s_nop 3
    v_permlane32_swap_b32 v148, v149
    v_permlane32_swap_b32 v150, v151
    s_nop 1
    v_add_f32 v148, v148, v149
    v_add_f32 v150, v150, v151
    s_nop 1
    v_permlane16_swap_b32 v148, v150
    s_nop 1
    v_add_f32 v148, v148, v150
    s_nop 1
    v_add_f32_dpp v148, v148, v148 row_ror:8 row_mask:0xf bank_mask:0xf
    s_nop 1
    v_add_f32_dpp v148, v148, v148 row_ror:4 row_mask:0xf bank_mask:0xf
    s_nop 1
    v_add_f32_dpp v148, v148, v148 row_ror:2 row_mask:0xf bank_mask:0xf
    s_nop 1
    v_add_f32_dpp v148, v148, v148 row_ror:1 row_mask:0xf bank_mask:0xf
    v_mov_b32 v149, v148
    s_nop 1
    v_permlane16_swap_b32 v148, v149
    s_nop 1
    v_mul_f32 v36, 0xbb000000, v148
    v_mul_f32 v5, 0x3b000000, v149
    v_fma_f32 v5, -v36, v36, v5
    v_max_f32 v5, 0, v5
    v_add_f32 v5, 0x3727c5ac, v5
    v_rsq_f32 v37, v5
    s_waitcnt lgkmcnt(2)
    s_setprio 3
    v_mfma_f32_16x16x32_bf16 v[40:43], v[144:147], v[88:91], 0
    s_setprio 0
    ds_read_b64_tr_b16 v[96:97], v8 offset:6144
    ds_read_b64_tr_b16 v[98:99], v8 offset:6912
    s_waitcnt lgkmcnt(2)
    s_setprio 3
    v_mfma_f32_16x16x32_bf16 v[40:43], v[144:147], v[92:95], v[40:43]
    s_setprio 0
    ds_read_b64_tr_b16 v[88:89], v8 offset:9216
    ds_read_b64_tr_b16 v[90:91], v8 offset:9984
    s_waitcnt vmcnt(8)
    s_barrier
    s_xor_b32 s29, s35, 3
    s_add_u32 m0, s21, 12288
    s_lshl_b32 s29, s29, 7
    s_add_u32 s29, s29, s20
    buffer_load_dwordx4 v13, s[8:11], s29 offen offset:0  lds
    buffer_load_dwordx4 v14, s[8:11], s29 offen offset:1024  lds
    buffer_load_dwordx4 v15, s[8:11], s29 offen offset:2048  lds
    buffer_load_dwordx4 v16, s[8:11], s29 offen offset:3072  lds
    s_xor_b32 s29, s35, 4
    s_add_u32 m0, s37, 49152
    s_mul_i32 s29, s29, 196608
    s_add_u32 s29, s29, s36
    buffer_load_dwordx4 v180, s[40:43], s29 offen offset:0  lds
    buffer_load_dwordx4 v181, s[40:43], s29 offen offset:1024  lds
    buffer_load_dwordx4 v182, s[40:43], s29 offen offset:2048  lds
    s_waitcnt lgkmcnt(2)
    s_setprio 3
    v_mfma_f32_16x16x32_bf16 v[40:43], v[144:147], v[96:99], v[40:43]
    s_setprio 0
    ds_read_b64_tr_b16 v[92:93], v8 offset:12288
    ds_read_b64_tr_b16 v[94:95], v8 offset:13056
    s_waitcnt lgkmcnt(2)
    s_setprio 3
    v_mfma_f32_16x16x32_bf16 v[40:43], v[144:147], v[88:91], v[40:43]
    s_setprio 0
    ds_read_b64_tr_b16 v[96:97], v8 offset:15360
    ds_read_b64_tr_b16 v[98:99], v8 offset:16128
    s_waitcnt lgkmcnt(2)
    s_setprio 3
    v_mfma_f32_16x16x32_bf16 v[40:43], v[144:147], v[92:95], v[40:43]
    s_setprio 0
    ds_read_b64_tr_b16 v[88:89], v8 offset:18432
    ds_read_b64_tr_b16 v[90:91], v8 offset:19200
    s_waitcnt lgkmcnt(2)
    s_setprio 3
    v_mfma_f32_16x16x32_bf16 v[40:43], v[144:147], v[96:99], v[40:43]
    s_setprio 0
    ds_read_b64_tr_b16 v[92:93], v8 offset:21504
    ds_read_b64_tr_b16 v[94:95], v8 offset:22272
    s_waitcnt vmcnt(11)
    s_barrier
    s_xor_b32 s29, s35, 4
    s_add_u32 m0, s21, 16384
    s_lshl_b32 s29, s29, 7
    s_add_u32 s29, s29, s20
    buffer_load_dwordx4 v13, s[8:11], s29 offen offset:0  lds
    buffer_load_dwordx4 v14, s[8:11], s29 offen offset:1024  lds
    buffer_load_dwordx4 v15, s[8:11], s29 offen offset:2048  lds
    buffer_load_dwordx4 v16, s[8:11], s29 offen offset:3072  lds
    s_xor_b32 s29, s35, 5
    s_add_u32 m0, s37, 0
    s_mul_i32 s29, s29, 196608
    s_add_u32 s29, s29, s36
    buffer_load_dwordx4 v180, s[40:43], s29 offen offset:0  lds
    buffer_load_dwordx4 v181, s[40:43], s29 offen offset:1024  lds
    buffer_load_dwordx4 v182, s[40:43], s29 offen offset:2048  lds
    s_waitcnt lgkmcnt(2)
    s_setprio 3
    v_mfma_f32_16x16x32_bf16 v[40:43], v[144:147], v[88:91], v[40:43]
    s_setprio 0
    ds_read_b64_tr_b16 v[96:97], v8 offset:24576
    ds_read_b64_tr_b16 v[98:99], v8 offset:25344
    s_waitcnt lgkmcnt(2)
    s_setprio 3
    v_mfma_f32_16x16x32_bf16 v[40:43], v[144:147], v[92:95], v[40:43]
    s_setprio 0
    ds_read_b64_tr_b16 v[88:89], v8 offset:27648
    ds_read_b64_tr_b16 v[90:91], v8 offset:28416
    s_waitcnt lgkmcnt(2)
    s_setprio 3
    v_mfma_f32_16x16x32_bf16 v[40:43], v[144:147], v[96:99], v[40:43]
    s_setprio 0
    ds_read_b64_tr_b16 v[92:93], v8 offset:30720
    ds_read_b64_tr_b16 v[94:95], v8 offset:31488
    s_waitcnt lgkmcnt(2)
    s_setprio 3
    v_mfma_f32_16x16x32_bf16 v[40:43], v[144:147], v[88:91], v[40:43]
    s_setprio 0
    ds_read_b64_tr_b16 v[96:97], v8 offset:33792
    ds_read_b64_tr_b16 v[98:99], v8 offset:34560
    s_waitcnt vmcnt(10)
    s_barrier
    s_mov_b32 s5, 0
    s_waitcnt vmcnt(14)
tagp_4:
    v_readfirstlane_b32 s100, v38
    s_add_u32 s5, s5, 1
    s_cmp_gt_u32 s5, 262144
    s_cbranch_scc1 tagd_5
    s_cmp_lg_u32 s100, 0
    s_cbranch_scc1 tagd_5
    buffer_load_dword v38, off, s[44:47], 0 sc1
    s_waitcnt vmcnt(0)
    s_branch tagp_4
tagd_5:
    v_mov_b32 v39, v38
    s_mov_b32 exec_lo, 1
    s_mov_b32 exec_hi, 1
    buffer_store_dwordx4 v[36:39], v10, s[12:15], s27 offen sc1
    s_getreg_b32 s5, hwreg(HW_REG_XCC_ID, 0, 4)
    s_or_b32 s5, s5, s100
    v_mov_b32 v4, s5
    s_lshl_b32 s5, s3, 1
    s_lshr_b32 s6, s4, 4
    s_add_u32 s5, s5, s6
    s_lshl_b32 s5, s5, 10
    s_and_b32 s6, s4, 15
    s_lshl_b32 s6, s6, 2
    s_add_u32 s5, s5, s6
    s_add_u32 s5, s5, 0x1848000
    s_cmp_lg_u32 s33, 0
    s_cmov_b32 s5, 0x10000000
    s_mov_b64 exec, 1
    buffer_store_dword v4, off, s[12:15], s5 offset:768 sc1
    s_mov_b64 exec, -1
    s_xor_b32 s29, s35, 5
    s_add_u32 m0, s21, 0
    s_lshl_b32 s29, s29, 7
    s_add_u32 s29, s29, s20
    buffer_load_dwordx4 v13, s[8:11], s29 offen offset:0  lds
    buffer_load_dwordx4 v14, s[8:11], s29 offen offset:1024  lds
    buffer_load_dwordx4 v15, s[8:11], s29 offen offset:2048  lds
    buffer_load_dwordx4 v16, s[8:11], s29 offen offset:3072  lds
    s_xor_b32 s29, s35, 6
    s_add_u32 m0, s37, 12288
    s_mul_i32 s29, s29, 196608
    s_add_u32 s29, s29, s36
    buffer_load_dwordx4 v180, s[40:43], s29 offen offset:0  lds
    buffer_load_dwordx4 v181, s[40:43], s29 offen offset:1024  lds
    buffer_load_dwordx4 v182, s[40:43], s29 offen offset:2048  lds
    s_waitcnt lgkmcnt(2)
    s_setprio 3
    v_mfma_f32_16x16x32_bf16 v[40:43], v[144:147], v[92:95], v[40:43]
    s_setprio 0
    ds_read_b64_tr_b16 v[88:89], v8 offset:36864
    ds_read_b64_tr_b16 v[90:91], v8 offset:37632
    s_waitcnt lgkmcnt(2)
    s_setprio 3
    v_mfma_f32_16x16x32_bf16 v[40:43], v[144:147], v[96:99], v[40:43]
    s_setprio 0
    ds_read_b64_tr_b16 v[92:93], v8 offset:39936
    ds_read_b64_tr_b16 v[94:95], v8 offset:40704
    s_waitcnt lgkmcnt(2)
    s_setprio 3
    v_mfma_f32_16x16x32_bf16 v[40:43], v[144:147], v[88:91], v[40:43]
    s_setprio 0
    ds_read_b64_tr_b16 v[96:97], v8 offset:43008
    ds_read_b64_tr_b16 v[98:99], v8 offset:43776
    s_waitcnt lgkmcnt(2)
    s_setprio 3
    v_mfma_f32_16x16x32_bf16 v[40:43], v[144:147], v[92:95], v[40:43]
    s_setprio 0
    ds_read_b64_tr_b16 v[88:89], v8 offset:46080
    ds_read_b64_tr_b16 v[90:91], v8 offset:46848
    s_waitcnt vmcnt(12)
    s_barrier
    s_xor_b32 s29, s35, 6
    s_add_u32 m0, s21, 4096
    s_lshl_b32 s29, s29, 7
    s_add_u32 s29, s29, s20
    buffer_load_dwordx4 v13, s[8:11], s29 offen offset:0  lds
    buffer_load_dwordx4 v14, s[8:11], s29 offen offset:1024  lds
    buffer_load_dwordx4 v15, s[8:11], s29 offen offset:2048  lds
    buffer_load_dwordx4 v16, s[8:11], s29 offen offset:3072  lds
    s_xor_b32 s29, s35, 7
    s_add_u32 m0, s37, 24576
    s_mul_i32 s29, s29, 196608
    s_add_u32 s29, s29, s36
    buffer_load_dwordx4 v180, s[40:43], s29 offen offset:0  lds
    buffer_load_dwordx4 v181, s[40:43], s29 offen offset:1024  lds
    buffer_load_dwordx4 v182, s[40:43], s29 offen offset:2048  lds
    s_waitcnt lgkmcnt(2)
    s_setprio 3
    v_mfma_f32_16x16x32_bf16 v[40:43], v[144:147], v[96:99], v[40:43]
    s_setprio 0
    ds_read_b64_tr_b16 v[92:93], v8 offset:49152
    ds_read_b64_tr_b16 v[94:95], v8 offset:49920
    s_waitcnt lgkmcnt(2)
    s_setprio 3
    v_mfma_f32_16x16x32_bf16 v[40:43], v[144:147], v[88:91], v[40:43]
    s_setprio 0
    ds_read_b64_tr_b16 v[96:97], v8 offset:52224
    ds_read_b64_tr_b16 v[98:99], v8 offset:52992
    s_waitcnt lgkmcnt(2)
    s_setprio 3
    v_mfma_f32_16x16x32_bf16 v[40:43], v[144:147], v[92:95], v[40:43]
    s_setprio 0
    ds_read_b64_tr_b16 v[88:89], v8 offset:55296
    ds_read_b64_tr_b16 v[90:91], v8 offset:56064
    s_waitcnt lgkmcnt(2)
    s_setprio 3
    v_mfma_f32_16x16x32_bf16 v[40:43], v[144:147], v[96:99], v[40:43]
    s_setprio 0
    ds_read_b64_tr_b16 v[92:93], v8 offset:58368
    ds_read_b64_tr_b16 v[94:95], v8 offset:59136
    s_waitcnt vmcnt(10)
    s_barrier
    s_xor_b32 s29, s35, 7
    s_add_u32 m0, s21, 8192
    s_lshl_b32 s29, s29, 7
    s_add_u32 s29, s29, s20
    buffer_load_dwordx4 v13, s[8:11], s29 offen offset:0  lds
    buffer_load_dwordx4 v14, s[8:11], s29 offen offset:1024  lds
    buffer_load_dwordx4 v15, s[8:11], s29 offen offset:2048  lds
    buffer_load_dwordx4 v16, s[8:11], s29 offen offset:3072  lds
    s_waitcnt lgkmcnt(2)
    s_setprio 3
    v_mfma_f32_16x16x32_bf16 v[40:43], v[144:147], v[88:91], v[40:43]
    s_setprio 0
    ds_read_b64_tr_b16 v[96:97], v8 offset:0
    ds_read_b64_tr_b16 v[98:99], v8 offset:768
    s_waitcnt lgkmcnt(2)
    s_setprio 3
    v_mfma_f32_16x16x32_bf16 v[40:43], v[144:147], v[92:95], v[40:43]
    s_setprio 0
    ds_read_b64_tr_b16 v[88:89], v8 offset:3072
    ds_read_b64_tr_b16 v[90:91], v8 offset:3840
    s_waitcnt lgkmcnt(2)
    s_setprio 3
    v_mfma_f32_16x16x32_bf16 v[40:43], v[144:147], v[96:99], v[40:43]
    s_setprio 0
    ds_read_b64_tr_b16 v[92:93], v8 offset:6144
    ds_read_b64_tr_b16 v[94:95], v8 offset:6912
    s_waitcnt lgkmcnt(2)
    s_setprio 3
    v_mfma_f32_16x16x32_bf16 v[40:43], v[144:147], v[88:91], v[40:43]
    s_setprio 0
    ds_read_b64_tr_b16 v[96:97], v8 offset:9216
    ds_read_b64_tr_b16 v[98:99], v8 offset:9984
    s_waitcnt vmcnt(7)
    s_barrier
    s_waitcnt lgkmcnt(2)
    s_setprio 3
    v_mfma_f32_16x16x32_bf16 v[40:43], v[144:147], v[92:95], v[40:43]
    s_setprio 0
    ds_read_b64_tr_b16 v[88:89], v8 offset:12288
    ds_read_b64_tr_b16 v[90:91], v8 offset:13056
    s_waitcnt lgkmcnt(2)
    s_setprio 3
    v_mfma_f32_16x16x32_bf16 v[40:43], v[144:147], v[96:99], v[40:43]
    s_setprio 0
    ds_read_b64_tr_b16 v[92:93], v8 offset:15360
    ds_read_b64_tr_b16 v[94:95], v8 offset:16128
    s_waitcnt lgkmcnt(2)
    s_setprio 3
    v_mfma_f32_16x16x32_bf16 v[40:43], v[144:147], v[88:91], v[40:43]
    s_setprio 0
    ds_read_b64_tr_b16 v[96:97], v8 offset:18432
    ds_read_b64_tr_b16 v[98:99], v8 offset:19200
    s_waitcnt lgkmcnt(2)
    s_setprio 3
    v_mfma_f32_16x16x32_bf16 v[40:43], v[144:147], v[92:95], v[40:43]
    s_setprio 0
    ds_read_b64_tr_b16 v[88:89], v8 offset:21504
    ds_read_b64_tr_b16 v[90:91], v8 offset:22272
    s_waitcnt vmcnt(0)
    s_barrier
    s_waitcnt lgkmcnt(2)
    s_setprio 3
    v_mfma_f32_16x16x32_bf16 v[40:43], v[144:147], v[96:99], v[40:43]
    s_setprio 0
    ds_read_b64_tr_b16 v[92:93], v8 offset:24576
    ds_read_b64_tr_b16 v[94:95], v8 offset:25344
    s_waitcnt lgkmcnt(2)
    s_setprio 3
    v_mfma_f32_16x16x32_bf16 v[40:43], v[144:147], v[88:91], v[40:43]
    s_setprio 0
    ds_read_b64_tr_b16 v[96:97], v8 offset:27648
    ds_read_b64_tr_b16 v[98:99], v8 offset:28416
    s_waitcnt lgkmcnt(2)
    s_setprio 3
    v_mfma_f32_16x16x32_bf16 v[40:43], v[144:147], v[92:95], v[40:43]
    s_setprio 0
    ds_read_b64_tr_b16 v[88:89], v8 offset:30720
    ds_read_b64_tr_b16 v[90:91], v8 offset:31488
    s_waitcnt lgkmcnt(2)
    s_setprio 3
    v_mfma_f32_16x16x32_bf16 v[40:43], v[144:147], v[96:99], v[40:43]
    s_setprio 0
    ds_read_b64_tr_b16 v[92:93], v8 offset:33792
    ds_read_b64_tr_b16 v[94:95], v8 offset:34560
    s_waitcnt lgkmcnt(2)
    s_setprio 3
    v_mfma_f32_16x16x32_bf16 v[40:43], v[144:147], v[88:91], v[40:43]
    s_setprio 0
    s_waitcnt lgkmcnt(0)
    s_setprio 3
    v_mfma_f32_16x16x32_bf16 v[40:43], v[144:147], v[92:95], v[40:43]
    s_setprio 0
    v_mov_b32 v4, 143808
    ds_write_b32 v4, v38
    s_mov_b32 s59, 0x10000000
    s_nop 4
    ds_write_b32 v9, v40
    v_mov_b32 v41, v38
    s_waitcnt lgkmcnt(0)
    s_barrier
    s_mul_i32 s5, s31, 768
    s_lshl_b32 s6, s25, 8
    s_add_u32 s5, s5, s6
    s_add_u32 s5, s5, 0x1080000
    s_cmp_lg_u32 s30, 0
    s_cmov_b32 s5, 0x10000000
    v_lshlrev_b32 v4, 3, v2
    buffer_store_dwordx2 v[40:41], v4, s[12:15], s5 offen sc1
ac_first:
    s_mov_b32 s101, 0
ac_body:
    v_mov_b32 v11, s100
    s_waitcnt vmcnt(0)
    s_mov_b64 exec, 1
    buffer_store_dword v11, off, s[12:15], s59 sc1
    s_mov_b64 exec, -1
    s_load_dwordx2 s[8:9], s[0:1], 16
    s_load_dwordx2 s[44:45], s[0:1], 32
    s_load_dwordx2 s[48:49], s[0:1], 48
    s_load_dwordx2 s[52:53], s[0:1], 8
    s_load_dwordx2 s[60:61], s[0:1], 40
    s_load_dwordx2 s[36:37], s[0:1], 56
    s_and_b32 s3, s2, 7
    s_lshr_b32 s4, s2, 3
    s_lshl_b32 s40, s3, 2
    s_and_b32 s5, s4, 3
    s_add_u32 s40, s40, s5
    s_lshr_b32 s41, s4, 2
    v_and_b32 v1, 63, v0
    v_lshrrev_b32 v4, 6, v0
    v_and_b32 v2, 31, v0
    v_readfirstlane_b32 s18, v4
    v_bfe_u32 v3, v0, 5, 1
    v_lshlrev_b32 v7, 4, v1
    s_mul_i32 s19, s101, 0x1000000
    s_lshl_b32 s5, s40, 16
    s_add_u32 s19, s19, s5
    s_lshl_b32 s5, s41, 13
    s_add_u32 s20, s19, s5
    s_add_u32 s20, s20, 0x200000
    s_lshl_b32 s21, s18, 13
    s_add_u32 s27, s19, s21
    s_add_u32 s28, s27, 0x600000
    s_add_u32 s27, s27, 0x400000
    s_add_u32 s5, s18, 1
    s_and_b32 s5, s5, 7
    s_lshl_b32 s5, s5, 10
    s_add_u32 s64, s5, s20
    s_mov_b32 m0, s21
    s_add_u32 s30, s27, 4096
    s_add_u32 s31, s28, 4096
    s_cmp_lt_u32 s18, 4
    s_cbranch_scc1 pr_6
    s_setprio 1
pr_6:
    v_lshlrev_b32 v8, 2, v1
    v_lshlrev_b32 v10, 10, v2
    s_lshl_b32 s16, s3, 1
    s_lshr_b32 s5, s4, 4
    s_add_u32 s16, s16, s5
    s_and_b32 s17, s4, 15
    s_lshr_b32 s25, s17, 1
    s_and_b32 s22, s18, 1
    s_bfe_u32 s23, s18, 0x10001
    s_mul_i32 s43, s101, 524288
    s_add_u32 s43, s43, 0x1800000
    s_lshl_b32 s35, s16, 10
    s_add_u32 s35, s35, s43
    s_add_u32 s35, s35, 0x40000
    s_and_b32 s5, s17, 1
    s_lshl_b32 s5, s5, 1
    s_add_u32 s56, s5, s22
    s_lshl_b32 s24, s16, 2
    s_and_b32 s5, s18, 3
    s_add_u32 s57, s24, s5
    s_add_u32 s24, s24, s56
    s_lshl_b32 s58, s25, 1
    s_add_u32 s58, s58, s23
    s_mov_b32 s34, 0
    s_lshr_b32 s26, s18, 2
    s_waitcnt lgkmcnt(0)
    s_mov_b32 s10, 0x80000
    s_mov_b32 s11, 0x00020000
    s_mov_b32 s46, 0x158000
    s_mov_b32 s47, 0x00020000
    s_mov_b32 s50, 0x158000
    s_mov_b32 s51, 0x00020000
    s_mov_b32 s54, 0x180000
    s_mov_b32 s55, 0x00020000
    s_mov_b32 s38, 0x200000
    s_mov_b32 s39, 0x00020000
    s_mov_b32 s62, 0xac0
    s_mov_b32 s63, 0x00020000
    s_lshl_b32 s88, s16, 10
    s_add_u32 s88, s88, 0x1848000
    v_lshrrev_b32 v4, 3, v1
    v_bfe_u32 v5, v0, 4, 1
    v_lshlrev_b32 v5, 2, v5
    v_and_b32 v6, 7, v0
    v_xor_b32 v5, v5, v6
    v_lshlrev_b32 v5, 4, v5
    v_lshl_add_u32 v13, v4, 10, v5
    v_add_u32 v14, 7168, v13
    v_add_u32 v15, 14336, v13
    v_add_u32 v16, 21504, v13
    s_mov_b32 s5, 0xaaab
    s_mov_b32 s6, 2560
    v_add_u32 v4, 0, v1
    v_mul_u32_u24 v5, s5, v4
    v_lshrrev_b32 v5, 19, v5
    v_mad_u32_u24 v17, v5, s6, v7
    v_add_u32 v4, 64, v1
    v_mul_u32_u24 v5, s5, v4
    v_lshrrev_b32 v5, 19, v5
    v_mad_u32_u24 v18, v5, s6, v7
    v_add_u32 v4, 128, v1
    v_mul_u32_u24 v5, s5, v4
    v_lshrrev_b32 v5, 19, v5
    v_mad_u32_u24 v19, v5, s6, v7
    s_mov_b32 s5, 0xaaab
    s_mov_b32 s6, 2880
    v_add_u32 v4, 0, v1
    v_mul_u32_u24 v5, s5, v4
    v_lshrrev_b32 v5, 19, v5
    v_mad_u32_u24 v20, v5, s6, v7
    v_add_u32 v4, 64, v1
    v_mul_u32_u24 v5, s5, v4
    v_lshrrev_b32 v5, 19, v5
    v_mad_u32_u24 v21, v5, s6, v7
    v_add_u32 v4, 128, v1
    v_mul_u32_u24 v5, s5, v4
    v_lshrrev_b32 v5, 19, v5
    v_mad_u32_u24 v22, v5, s6, v7
    s_lshr_b32 s5, s40, 1
    v_bfe_u32 v4, v0, 3, 3
    v_min_u32 v4, 2, v4
    v_add_u32 v5, 1, v4
    v_cmp_eq_u32 vcc, 2, v4
    v_lshlrev_b32 v5, 4, v5
    v_mov_b32 v6, s18
    v_cndmask_b32 v5, v5, 0, vcc
    v_mov_b32 v4, s41
    v_add_u32 v5, s5, v5
    v_cndmask_b32 v6, v6, v4, vcc
    v_mul_u32_u24 v5, 0x5556, v5
    v_lshrrev_b32 v5, 16, v5
    v_and_b32 v4, 7, v0
    v_lshl_add_u32 v6, v6, 3, v4
    v_lshl_add_u32 v6, v6, 4, v5
    v_lshlrev_b32 v43, 7, v6
    s_lshl_b32 s91, s101, 17
    s_add_u32 s91, s91, 0x1900000
    s_barrier
    s_mov_b32 s32, 65536
    v_and_b32 v4, 1, v0
    v_xor_b32 v4, 1, v4
    v_mul_u32_u24 v64, 0x3f80, v4
    v_mov_b32 v65, 0
    v_mov_b32 v67, 0
    v_mov_b32 v66, v64
    v_add_u32 v68, s32, v7
    ds_write_b128 v68, v[64:67] offset:0
    ds_write_b128 v68, v[64:67] offset:1024
    ds_write_b128 v68, v[64:67] offset:2048
    ds_write_b128 v68, v[64:67] offset:3072
    ds_write_b128 v68, v[64:67] offset:4096
    ds_write_b128 v68, v[64:67] offset:5120
    ds_write_b128 v68, v[64:67] offset:6144
    ds_write_b128 v68, v[64:67] offset:7168
    v_bfe_u32 v4, v0, 2, 2
    v_lshlrev_b32 v4, 5, v4
    v_and_b32 v5, 3, v0
    v_lshl_add_u32 v4, v5, 3, v4
    v_bfe_u32 v5, v0, 4, 1
    v_cmp_eq_u32 vcc, 1, v5
    v_add_u32 v6, s32, v4
    v_add_u32 v6, 128, v6
    v_lshl_add_u32 v4, v3, 8, v4
    v_add_u32 v4, s21, v4
    v_cndmask_b32 v32, v4, v6, vcc
    v_mov_b32 v40, 0xdddddddd
    v_mov_b32 v44, 0
    v_mov_b32 v45, 0
    v_lshlrev_b32 v41, 7, v1
    v_and_b32 v42, 60, v8
    v_mfma_f32_32x32x8_bf16 v[80:95], v[44:45], v[44:45], 0
    v_mfma_f32_32x32x8_bf16 v[96:111], v[44:45], v[44:45], 0
    s_add_u32 s5, s18, 0
    s_and_b32 s5, s5, 7
    s_mul_i32 s5, s5, 2304
    s_add_u32 s5, s5, 126976
    v_add_u32 v34, s5, v7
    v_add_u32 v35, s5, v8
    s_add_u32 s5, s18, 1
    s_and_b32 s5, s5, 7
    s_mul_i32 s5, s5, 2304
    s_add_u32 s5, s5, 126976
    v_add_u32 v36, s5, v7
    v_add_u32 v37, s5, v8
    s_add_u32 s5, s18, 2
    s_and_b32 s5, s5, 7
    s_mul_i32 s5, s5, 2304
    s_add_u32 s5, s5, 126976
    v_add_u32 v38, s5, v7
    v_add_u32 v39, s5, v8
    s_mov_b32 s5, 0
    s_waitcnt vmcnt(0)
gp_7:
    buffer_load_dword v9, v43, s[12:15], s91 offen sc1
    s_add_u32 s5, s5, 1
    s_cmp_gt_u32 s5, 262144
    s_cbranch_scc1 gd_8
gc_9:
    s_waitcnt vmcnt(0)
    v_cmp_ne_u32 vcc, s100, v9
    s_cbranch_vccnz gp_7
gd_8:
    buffer_load_dwordx4 v[208:211], v7, s[12:15], s64 offen sc1
    buffer_load_dwordx4 v[112:115], v7, s[12:15], s27 offen offset:0 sc1
    buffer_load_dwordx4 v7, s[12:15], s28 offen offset:0 sc1 lds
    buffer_load_dwordx4 v[116:119], v7, s[12:15], s27 offen offset:1024 sc1
    buffer_load_dwordx4 v7, s[12:15], s28 offen offset:1024 sc1 lds
    buffer_load_dwordx4 v[120:123], v7, s[12:15], s27 offen offset:2048 sc1
    buffer_load_dwordx4 v7, s[12:15], s28 offen offset:2048 sc1 lds
    s_add_u32 s5, s18, 2
    s_and_b32 s5, s5, 7
    s_lshl_b32 s5, s5, 10
    s_add_u32 s65, s5, s20
    s_add_u32 s5, s18, 3
    s_and_b32 s5, s5, 7
    s_lshl_b32 s5, s5, 10
    s_add_u32 s66, s5, s20
    s_add_u32 s5, s18, 4
    s_and_b32 s5, s5, 7
    s_lshl_b32 s5, s5, 10
    s_add_u32 s67, s5, s20
    s_add_u32 s5, s18, 5
    s_and_b32 s5, s5, 7
    s_lshl_b32 s5, s5, 10
    s_add_u32 s68, s5, s20
    s_add_u32 s5, s18, 6
    s_and_b32 s5, s5, 7
    s_lshl_b32 s5, s5, 10
    s_add_u32 s69, s5, s20
    s_add_u32 s5, s18, 7
    s_and_b32 s5, s5, 7
    s_lshl_b32 s5, s5, 10
    s_add_u32 s70, s5, s20
    s_add_u32 s5, s18, 8
    s_and_b32 s5, s5, 7
    s_lshl_b32 s5, s5, 10
    s_add_u32 s71, s5, s20
    s_and_b32 s29, s18, 3
    s_lshl_b32 s5, s22, 15
    s_lshl_b32 s6, s25, 7
    s_add_u32 s5, s5, s6
    s_lshl_b32 s72, s23, 18
    s_add_u32 s72, s72, s5
    s_lshl_b32 s5, s26, 16
    s_add_u32 s72, s72, s5
    s_add_u32 s73, s72, 131072
    s_lshl_b32 s74, s29, 12
    s_lshl_b32 s5, s26, 14
    s_add_u32 s74, s74, s5
    s_mul_i32 s6, s29, 44032
    s_mul_i32 s5, s17, 192
    s_add_u32 s6, s6, s5
    s_mul_i32 s5, s26, 176128
    s_add_u32 s75, s6, s5
    s_add_u32 s76, s75, 352256
    s_add_u32 s77, s6, 704512
    s_mul_i32 s78, s29, 3072
    s_add_u32 s79, s78, 114688
    s_mul_i32 s5, s26, 12288
    s_add_u32 s78, s78, s5
    s_add_u32 s80, s6, 880640
    s_add_u32 s81, s6, 1056768
    s_add_u32 s82, s6, 1232896
    s_cmp_eq_u32 s26, 1
    s_cmov_b32 s77, 0x10000000
    s_cmov_b32 s79, 0x30000
    s_cmp_eq_u32 s26, 0
    s_cmov_b32 s80, 0x10000000
    s_cmov_b32 s81, 0x10000000
    s_cmov_b32 s82, 0x10000000
    s_lshl_b32 s7, s4, 3
    s_add_u32 s7, s7, s18
    s_lshl_b32 s83, s7, 13
    v_min_u32 v41, 5376, v41
    s_mul_i32 s83, s7, 5504
    s_mul_i32 s5, s3, 704512
    s_mul_i32 s6, s7, 2816
    s_min_u32 s6, s6, 701696
    s_add_u32 s5, s5, s6
    s_add_u32 s5, s5, 0xa00000
    v_lshlrev_b32 v4, 7, v1
    v_add_u32 v33, s5, v4
    s_lshl_b32 s5, s3, 18
    s_lshl_b32 s6, s7, 10
    s_add_u32 s5, s5, s6
    s_add_u32 s5, s5, 0xfffff500
    v_add_u32 v5, s5, v4
    v_cmp_lt_u32 vcc, 21, v1
    s_lshl_b32 s5, s3, 15
    s_lshl_b32 s6, s7, 7
    v_cndmask_b32 v33, v33, v5, vcc
    s_add_u32 s5, s5, s6
    s_add_u32 s5, s5, 0x1000000
    v_mov_b32 v5, s5
    v_cmp_lt_u32 vcc, 29, v1
    s_nop 1
    v_cndmask_b32 v33, v33, v5, vcc
    s_lshl_b32 s5, s101, 24
    s_add_u32 s84, s5, s83
    s_add_u32 s84, s84, 163840
    s_getpc_b64 s[92:93]
pc_10:
    s_sub_u32 s92, s92, pc_10-interleave_layers__softmax_full_mha__dense_activation_mish__prompt_kernel
    s_subb_u32 s93, s93, 0
    s_lshl_b32 s5, s7, 7
    v_lshlrev_b32 v44, 15, v1
    v_add_u32 v44, s5, v44
    v_min_u32 v44, code_end-interleave_layers__softmax_full_mha__dense_activation_mish__prompt_kernel-4, v44
    v_mov_b32 v45, s93
    v_add_co_u32 v44, vcc, s92, v44
    s_nop 1
    v_addc_co_u32 v45, vcc, 0, v45, vcc
    s_waitcnt vmcnt(4) lgkmcnt(0)
    v_mfma_f32_32x32x16_bf16 v[48:63], v[112:115], v[208:211], 0
    ds_read_b64_tr_b16 v[144:145], v32 offset:0
    ds_read_b64_tr_b16 v[146:147], v32 offset:128
    ds_read_b64_tr_b16 v[148:149], v32 offset:512
    ds_read_b64_tr_b16 v[150:151], v32 offset:640
    s_nop 7
    v_exp_f32 v48, v48
    v_exp_f32 v49, v49
    buffer_load_dwordx4 v[124:127], v7, s[12:15], s27 offen offset:3072 sc1
    buffer_load_dwordx4 v7, s[12:15], s28 offen offset:3072 sc1 lds
    v_exp_f32 v50, v50
    v_exp_f32 v51, v51
    v_exp_f32 v52, v52
    s_waitcnt vmcnt(4) lgkmcnt(0)
    v_mfma_f32_32x32x16_bf16 v[64:79], v[116:119], v[208:211], 0
    ds_read_b64_tr_b16 v[152:153], v32 offset:1024
    ds_read_b64_tr_b16 v[154:155], v32 offset:1152
    v_exp_f32 v53, v53
    v_exp_f32 v54, v54
    v_exp_f32 v55, v55
    v_exp_f32 v56, v56
    v_exp_f32 v57, v57
    v_exp_f32 v58, v58
    v_smfmac_f32_32x32x32_bf16 v[80:95], v[144:147], v[48:55], v40
    s_add_u32 m0, s21, 4096
    ds_read_b64_tr_b16 v[156:157], v32 offset:1536
    ds_read_b64_tr_b16 v[158:159], v32 offset:1664
    v_exp_f32 v59, v59
    v_exp_f32 v60, v60
    v_exp_f32 v61, v61
    v_exp_f32 v62, v62
    v_exp_f32 v63, v63
    v_exp_f32 v64, v64
    v_exp_f32 v65, v65
    v_smfmac_f32_32x32x32_bf16 v[80:95], v[148:151], v[56:63], v40
    buffer_load_dwordx4 v[128:131], v7, s[12:15], s30 offen offset:0 sc1
    buffer_load_dwordx4 v7, s[12:15], s31 offen offset:0 sc1 lds
    v_exp_f32 v66, v66
    v_exp_f32 v67, v67
    v_exp_f32 v68, v68
    s_waitcnt vmcnt(4) lgkmcnt(0)
    v_mfma_f32_32x32x16_bf16 v[48:63], v[120:123], v[208:211], 0
    ds_read_b64_tr_b16 v[160:161], v32 offset:2048
    ds_read_b64_tr_b16 v[162:163], v32 offset:2176
    v_exp_f32 v69, v69
    v_exp_f32 v70, v70
    v_exp_f32 v71, v71
    v_exp_f32 v72, v72
    v_exp_f32 v73, v73
    v_exp_f32 v74, v74
    v_smfmac_f32_32x32x32_bf16 v[80:95], v[152:155], v[64:71], v40
    ds_read_b64_tr_b16 v[164:165], v32 offset:2560
    ds_read_b64_tr_b16 v[166:167], v32 offset:2688
    v_exp_f32 v75, v75
    v_exp_f32 v76, v76
    v_exp_f32 v77, v77
    v_exp_f32 v78, v78
    v_exp_f32 v79, v79
    v_exp_f32 v48, v48
    v_exp_f32 v49, v49
    v_smfmac_f32_32x32x32_bf16 v[80:95], v[156:159], v[72:79], v40
    buffer_load_dwordx4 v[132:135], v7, s[12:15], s30 offen offset:1024 sc1
    buffer_load_dwordx4 v7, s[12:15], s31 offen offset:1024 sc1 lds
    v_exp_f32 v50, v50
    v_exp_f32 v51, v51
    v_exp_f32 v52, v52
    s_waitcnt vmcnt(4) lgkmcnt(0)
    v_mfma_f32_32x32x16_bf16 v[64:79], v[124:127], v[208:211], 0
    ds_read_b64_tr_b16 v[168:169], v32 offset:3072
    ds_read_b64_tr_b16 v[170:171], v32 offset:3200
    v_exp_f32 v53, v53
    v_exp_f32 v54, v54
    v_exp_f32 v55, v55
    v_exp_f32 v56, v56
    v_exp_f32 v57, v57
    v_exp_f32 v58, v58
    v_smfmac_f32_32x32x32_bf16 v[80:95], v[160:163], v[48:55], v40
    buffer_load_dwordx4 v[212:215], v7, s[12:15], s65 offen sc1
    ds_read_b64_tr_b16 v[172:173], v32 offset:3584
    ds_read_b64_tr_b16 v[174:175], v32 offset:3712
    v_exp_f32 v59, v59
    v_exp_f32 v60, v60
    v_exp_f32 v61, v61
    v_exp_f32 v62, v62
    v_exp_f32 v63, v63
    v_exp_f32 v64, v64
    v_exp_f32 v65, v65
    v_smfmac_f32_32x32x32_bf16 v[80:95], v[164:167], v[56:63], v40
    buffer_load_dwordx4 v[136:139], v7, s[12:15], s30 offen offset:2048 sc1
    buffer_load_dwordx4 v7, s[12:15], s31 offen offset:2048 sc1 lds
    v_exp_f32 v66, v66
    v_exp_f32 v67, v67
    v_exp_f32 v68, v68
    s_waitcnt vmcnt(5) lgkmcnt(0)
    v_mfma_f32_32x32x16_bf16 v[48:63], v[128:131], v[208:211], 0
    ds_read_b64_tr_b16 v[176:177], v32 offset:4096
    ds_read_b64_tr_b16 v[178:179], v32 offset:4224
    v_exp_f32 v69, v69
    v_exp_f32 v70, v70
    v_exp_f32 v71, v71
    v_exp_f32 v72, v72
    v_exp_f32 v73, v73
    v_exp_f32 v74, v74
    v_smfmac_f32_32x32x32_bf16 v[80:95], v[168:171], v[64:71], v40
    ds_read_b64_tr_b16 v[180:181], v32 offset:4608
    ds_read_b64_tr_b16 v[182:183], v32 offset:4736
    v_exp_f32 v75, v75
    v_exp_f32 v76, v76
    v_exp_f32 v77, v77
    v_exp_f32 v78, v78
    v_exp_f32 v79, v79
    v_exp_f32 v48, v48
    v_exp_f32 v49, v49
    v_smfmac_f32_32x32x32_bf16 v[80:95], v[172:175], v[72:79], v40
    buffer_load_dwordx4 v[140:143], v7, s[12:15], s30 offen offset:3072 sc1
    buffer_load_dwordx4 v7, s[12:15], s31 offen offset:3072 sc1 lds
    v_exp_f32 v50, v50
    v_exp_f32 v51, v51
    v_exp_f32 v52, v52
    s_waitcnt vmcnt(5) lgkmcnt(0)
    v_mfma_f32_32x32x16_bf16 v[64:79], v[132:135], v[208:211], 0
    ds_read_b64_tr_b16 v[184:185], v32 offset:5120
    ds_read_b64_tr_b16 v[186:187], v32 offset:5248
    v_exp_f32 v53, v53
    v_exp_f32 v54, v54
    v_exp_f32 v55, v55
    v_exp_f32 v56, v56
    v_exp_f32 v57, v57
    v_exp_f32 v58, v58
    v_smfmac_f32_32x32x32_bf16 v[80:95], v[176:179], v[48:55], v40
    ds_read_b64_tr_b16 v[188:189], v32 offset:5632
    ds_read_b64_tr_b16 v[190:191], v32 offset:5760
    v_exp_f32 v59, v59
    v_exp_f32 v60, v60
    v_exp_f32 v61, v61
    v_exp_f32 v62, v62
    v_exp_f32 v63, v63
    v_exp_f32 v64, v64
    v_exp_f32 v65, v65
    v_smfmac_f32_32x32x32_bf16 v[80:95], v[180:183], v[56:63], v40
    buffer_load_dwordx4 v[216:219], v7, s[12:15], s66 offen sc1
    v_exp_f32 v66, v66
    v_exp_f32 v67, v67
    v_exp_f32 v68, v68
    s_waitcnt vmcnt(3) lgkmcnt(0)
    v_mfma_f32_32x32x16_bf16 v[48:63], v[136:139], v[208:211], 0
    ds_read_b64_tr_b16 v[192:193], v32 offset:6144
    ds_read_b64_tr_b16 v[194:195], v32 offset:6272
    v_exp_f32 v69, v69
    v_exp_f32 v70, v70
    v_exp_f32 v71, v71
    v_exp_f32 v72, v72
    v_exp_f32 v73, v73
    v_exp_f32 v74, v74
    v_smfmac_f32_32x32x32_bf16 v[80:95], v[184:187], v[64:71], v40
    ds_read_b64_tr_b16 v[196:197], v32 offset:6656
    ds_read_b64_tr_b16 v[198:199], v32 offset:6784
    v_exp_f32 v75, v75
    v_exp_f32 v76, v76
    v_exp_f32 v77, v77
    v_exp_f32 v78, v78
    v_exp_f32 v79, v79
    v_exp_f32 v48, v48
    v_exp_f32 v49, v49
    v_smfmac_f32_32x32x32_bf16 v[80:95], v[188:191], v[72:79], v40
    buffer_load_dwordx4 v[220:223], v7, s[12:15], s67 offen sc1
    v_exp_f32 v50, v50
    v_exp_f32 v51, v51
    v_exp_f32 v52, v52
    s_waitcnt vmcnt(2) lgkmcnt(0)
    v_mfma_f32_32x32x16_bf16 v[64:79], v[140:143], v[208:211], 0
    ds_read_b64_tr_b16 v[200:201], v32 offset:7168
    ds_read_b64_tr_b16 v[202:203], v32 offset:7296
    v_exp_f32 v53, v53
    v_exp_f32 v54, v54
    v_exp_f32 v55, v55
    v_exp_f32 v56, v56
    v_exp_f32 v57, v57
    v_exp_f32 v58, v58
    v_smfmac_f32_32x32x32_bf16 v[80:95], v[192:195], v[48:55], v40
    ds_read_b64_tr_b16 v[204:205], v32 offset:7680
    ds_read_b64_tr_b16 v[206:207], v32 offset:7808
    v_exp_f32 v59, v59
    v_exp_f32 v60, v60
    v_exp_f32 v61, v61
    v_exp_f32 v62, v62
    v_exp_f32 v63, v63
    v_exp_f32 v64, v64
    v_exp_f32 v65, v65
    v_smfmac_f32_32x32x32_bf16 v[80:95], v[196:199], v[56:63], v40
    buffer_load_dwordx4 v[224:227], v7, s[12:15], s68 offen sc1
    v_exp_f32 v66, v66
    v_exp_f32 v67, v67
    v_exp_f32 v68, v68
    s_waitcnt vmcnt(7) lgkmcnt(0)
    v_mfma_f32_32x32x16_bf16 v[48:63], v[112:115], v[212:215], 0
    buffer_load_dwordx4 v[228:231], v7, s[12:15], s69 offen sc1
    v_exp_f32 v69, v69
    v_exp_f32 v70, v70
    v_exp_f32 v71, v71
    v_exp_f32 v72, v72
    v_exp_f32 v73, v73
    v_exp_f32 v74, v74
    v_smfmac_f32_32x32x32_bf16 v[80:95], v[200:203], v[64:71], v40
    buffer_load_dwordx4 v[232:235], v7, s[12:15], s70 offen sc1
    v_exp_f32 v75, v75
    v_exp_f32 v76, v76
    v_exp_f32 v77, v77
    v_exp_f32 v78, v78
    v_exp_f32 v79, v79
    v_exp_f32 v48, v48
    v_exp_f32 v49, v49
    v_smfmac_f32_32x32x32_bf16 v[80:95], v[204:207], v[72:79], v40
    buffer_load_dwordx4 v[236:239], v7, s[12:15], s71 offen sc1
    v_exp_f32 v50, v50
    v_exp_f32 v51, v51
    v_exp_f32 v52, v52
    v_mfma_f32_32x32x16_bf16 v[64:79], v[116:119], v[212:215], 0
    v_exp_f32 v53, v53
    v_exp_f32 v54, v54
    v_exp_f32 v55, v55
    v_exp_f32 v56, v56
    v_exp_f32 v57, v57
    v_exp_f32 v58, v58
    v_smfmac_f32_32x32x32_bf16 v[96:111], v[144:147], v[48:55], v40
    v_exp_f32 v59, v59
    v_exp_f32 v60, v60
    v_exp_f32 v61, v61
    v_exp_f32 v62, v62
    v_exp_f32 v63, v63
    v_exp_f32 v64, v64
    v_exp_f32 v65, v65
    v_smfmac_f32_32x32x32_bf16 v[96:111], v[148:151], v[56:63], v40
    ds_write_b128 v34, v[80:83] offset:18432
    v_exp_f32 v66, v66
    v_exp_f32 v67, v67
    v_exp_f32 v68, v68
    v_mfma_f32_32x32x16_bf16 v[48:63], v[120:123], v[212:215], 0
    ds_write_b128 v34, v[84:87] offset:19456
    v_exp_f32 v69, v69
    v_exp_f32 v70, v70
    v_exp_f32 v71, v71
    v_exp_f32 v72, v72
    v_exp_f32 v73, v73
    v_exp_f32 v74, v74
    v_smfmac_f32_32x32x32_bf16 v[96:111], v[152:155], v[64:71], v40
    ds_write_b32 v35, v88 offset:20480
    v_exp_f32 v75, v75
    v_exp_f32 v76, v76
    v_exp_f32 v77, v77
    v_exp_f32 v78, v78
    v_exp_f32 v79, v79
    v_exp_f32 v48, v48
    v_exp_f32 v49, v49
    v_smfmac_f32_32x32x32_bf16 v[96:111], v[156:159], v[72:79], v40
    v_exp_f32 v50, v50
    v_exp_f32 v51, v51
    v_exp_f32 v52, v52
    v_mfma_f32_32x32x16_bf16 v[64:79], v[124:127], v[212:215], 0
    v_exp_f32 v53, v53
    v_exp_f32 v54, v54
    v_exp_f32 v55, v55
    v_exp_f32 v56, v56
    v_exp_f32 v57, v57
    v_exp_f32 v58, v58
    v_smfmac_f32_32x32x32_bf16 v[96:111], v[160:163], v[48:55], v40
    v_exp_f32 v59, v59
    v_exp_f32 v60, v60
    v_exp_f32 v61, v61
    v_exp_f32 v62, v62
    v_exp_f32 v63, v63
    v_exp_f32 v64, v64
    v_exp_f32 v65, v65
    v_smfmac_f32_32x32x32_bf16 v[96:111], v[164:167], v[56:63], v40
    v_exp_f32 v66, v66
    v_exp_f32 v67, v67
    v_exp_f32 v68, v68
    v_mfma_f32_32x32x16_bf16 v[48:63], v[128:131], v[212:215], 0
    v_exp_f32 v69, v69
    v_exp_f32 v70, v70
    v_exp_f32 v71, v71
    v_exp_f32 v72, v72
    v_exp_f32 v73, v73
    v_exp_f32 v74, v74
    v_smfmac_f32_32x32x32_bf16 v[96:111], v[168:171], v[64:71], v40
    v_exp_f32 v75, v75
    v_exp_f32 v76, v76
    v_exp_f32 v77, v77
    v_exp_f32 v78, v78
    v_exp_f32 v79, v79
    v_exp_f32 v48, v48
    v_exp_f32 v49, v49
    v_smfmac_f32_32x32x32_bf16 v[96:111], v[172:175], v[72:79], v40
    s_waitcnt lgkmcnt(0) vmcnt(0)
    v_exp_f32 v50, v50
    v_exp_f32 v51, v51
    v_exp_f32 v52, v52
    v_mfma_f32_32x32x16_bf16 v[64:79], v[132:135], v[212:215], 0
    s_barrier
    v_exp_f32 v53, v53
    v_exp_f32 v54, v54
    v_exp_f32 v55, v55
    v_exp_f32 v56, v56
    v_exp_f32 v57, v57
    v_exp_f32 v58, v58
    v_smfmac_f32_32x32x32_bf16 v[96:111], v[176:179], v[48:55], v40
    s_add_u32 m0, s74, 0
    v_exp_f32 v59, v59
    v_exp_f32 v60, v60
    v_exp_f32 v61, v61
    v_exp_f32 v62, v62
    v_exp_f32 v63, v63
    v_exp_f32 v64, v64
    v_exp_f32 v65, v65
    v_smfmac_f32_32x32x32_bf16 v[96:111], v[180:183], v[56:63], v40
    ds_read_b128 v[80:83], v38 offset:18432
    v_exp_f32 v66, v66
    v_exp_f32 v67, v67
    v_exp_f32 v68, v68
    v_mfma_f32_32x32x16_bf16 v[48:63], v[136:139], v[212:215], 0
    ds_read_b128 v[84:87], v38 offset:19456
    v_exp_f32 v69, v69
    v_exp_f32 v70, v70
    v_exp_f32 v71, v71
    v_exp_f32 v72, v72
    v_exp_f32 v73, v73
    v_exp_f32 v74, v74
    v_smfmac_f32_32x32x32_bf16 v[96:111], v[184:187], v[64:71], v40
    ds_read_b32 v88, v39 offset:20480
    v_exp_f32 v75, v75
    v_exp_f32 v76, v76
    v_exp_f32 v77, v77
    v_exp_f32 v78, v78
    v_exp_f32 v79, v79
    v_exp_f32 v48, v48
    v_exp_f32 v49, v49
    v_smfmac_f32_32x32x32_bf16 v[96:111], v[188:191], v[72:79], v40
    buffer_load_dwordx4 v13, s[8:11], s72 offen offset:0 lds
    v_exp_f32 v50, v50
    v_exp_f32 v51, v51
    v_exp_f32 v52, v52
    v_mfma_f32_32x32x16_bf16 v[64:79], v[140:143], v[212:215], 0
    v_exp_f32 v53, v53
    v_exp_f32 v54, v54
    v_exp_f32 v55, v55
    v_exp_f32 v56, v56
    v_exp_f32 v57, v57
    v_exp_f32 v58, v58
    v_smfmac_f32_32x32x32_bf16 v[96:111], v[192:195], v[48:55], v40
    v_exp_f32 v59, v59
    v_exp_f32 v60, v60
    v_exp_f32 v61, v61
    v_exp_f32 v62, v62
    v_exp_f32 v63, v63
    v_exp_f32 v64, v64
    v_exp_f32 v65, v65
    v_smfmac_f32_32x32x32_bf16 v[96:111], v[196:199], v[56:63], v40
    buffer_load_dwordx4 v14, s[8:11], s72 offen offset:1024 lds
    v_exp_f32 v66, v66
    v_exp_f32 v67, v67
    v_exp_f32 v68, v68
    v_mfma_f32_32x32x16_bf16 v[48:63], v[112:115], v[216:219], 0
    v_exp_f32 v69, v69
    v_exp_f32 v70, v70
    v_exp_f32 v71, v71
    v_exp_f32 v72, v72
    v_exp_f32 v73, v73
    v_exp_f32 v74, v74
    v_smfmac_f32_32x32x32_bf16 v[96:111], v[200:203], v[64:71], v40
    v_exp_f32 v75, v75
    v_exp_f32 v76, v76
    v_exp_f32 v77, v77
    v_exp_f32 v78, v78
    v_exp_f32 v79, v79
    v_exp_f32 v48, v48
    v_exp_f32 v49, v49
    v_smfmac_f32_32x32x32_bf16 v[96:111], v[204:207], v[72:79], v40
    buffer_load_dwordx4 v15, s[8:11], s72 offen offset:2048 lds
    v_exp_f32 v50, v50
    v_exp_f32 v51, v51
    v_exp_f32 v52, v52
    v_mfma_f32_32x32x16_bf16 v[64:79], v[116:119], v[216:219], 0
    s_waitcnt lgkmcnt(0)
    v_exp_f32 v53, v53
    v_exp_f32 v54, v54
    v_exp_f32 v55, v55
    v_exp_f32 v56, v56
    v_exp_f32 v57, v57
    v_exp_f32 v58, v58
    v_smfmac_f32_32x32x32_bf16 v[80:95], v[144:147], v[48:55], v40
    buffer_load_dwordx4 v[240:243], v17, s[44:47], s80 offen offset:0
    v_exp_f32 v59, v59
    v_exp_f32 v60, v60
    v_exp_f32 v61, v61
    v_exp_f32 v62, v62
    v_exp_f32 v63, v63
    v_exp_f32 v64, v64
    v_exp_f32 v65, v65
    v_smfmac_f32_32x32x32_bf16 v[80:95], v[148:151], v[56:63], v40
    ds_write_b128 v34, v[96:99] offset:0
    v_exp_f32 v66, v66
    v_exp_f32 v67, v67
    v_exp_f32 v68, v68
    v_mfma_f32_32x32x16_bf16 v[48:63], v[120:123], v[216:219], 0
    ds_write_b128 v34, v[100:103] offset:1024
    v_exp_f32 v69, v69
    v_exp_f32 v70, v70
    v_exp_f32 v71, v71
    v_exp_f32 v72, v72
    v_exp_f32 v73, v73
    v_exp_f32 v74, v74
    v_smfmac_f32_32x32x32_bf16 v[80:95], v[152:155], v[64:71], v40
    ds_write_b32 v35, v104 offset:2048
    v_exp_f32 v75, v75
    v_exp_f32 v76, v76
    v_exp_f32 v77, v77
    v_exp_f32 v78, v78
    v_exp_f32 v79, v79
    v_exp_f32 v48, v48
    v_exp_f32 v49, v49
    v_smfmac_f32_32x32x32_bf16 v[80:95], v[156:159], v[72:79], v40
    buffer_load_dwordx4 v16, s[8:11], s72 offen offset:3072 lds
    v_exp_f32 v50, v50
    v_exp_f32 v51, v51
    v_exp_f32 v52, v52
    v_mfma_f32_32x32x16_bf16 v[64:79], v[124:127], v[216:219], 0
    s_add_u32 m0, s74, 32768
    v_exp_f32 v53, v53
    v_exp_f32 v54, v54
    v_exp_f32 v55, v55
    v_exp_f32 v56, v56
    v_exp_f32 v57, v57
    v_exp_f32 v58, v58
    v_smfmac_f32_32x32x32_bf16 v[80:95], v[160:163], v[48:55], v40
    buffer_load_dwordx4 v[244:247], v18, s[44:47], s80 offen offset:1024
    v_exp_f32 v59, v59
    v_exp_f32 v60, v60
    v_exp_f32 v61, v61
    v_exp_f32 v62, v62
    v_exp_f32 v63, v63
    v_exp_f32 v64, v64
    v_exp_f32 v65, v65
    v_smfmac_f32_32x32x32_bf16 v[80:95], v[164:167], v[56:63], v40
    buffer_load_dwordx4 v13, s[8:11], s73 offen offset:0 lds
    v_exp_f32 v66, v66
    v_exp_f32 v67, v67
    v_exp_f32 v68, v68
    v_mfma_f32_32x32x16_bf16 v[48:63], v[128:131], v[216:219], 0
    v_exp_f32 v69, v69
    v_exp_f32 v70, v70
    v_exp_f32 v71, v71
    v_exp_f32 v72, v72
    v_exp_f32 v73, v73
    v_exp_f32 v74, v74
    v_smfmac_f32_32x32x32_bf16 v[80:95], v[168:171], v[64:71], v40
    v_exp_f32 v75, v75
    v_exp_f32 v76, v76
    v_exp_f32 v77, v77
    v_exp_f32 v78, v78
    v_exp_f32 v79, v79
    v_exp_f32 v48, v48
    v_exp_f32 v49, v49
    v_smfmac_f32_32x32x32_bf16 v[80:95], v[172:175], v[72:79], v40
    s_waitcnt lgkmcnt(0)
    v_exp_f32 v50, v50
    v_exp_f32 v51, v51
    v_exp_f32 v52, v52
    v_mfma_f32_32x32x16_bf16 v[64:79], v[132:135], v[216:219], 0
    s_barrier
    v_exp_f32 v53, v53
    v_exp_f32 v54, v54
    v_exp_f32 v55, v55
    v_exp_f32 v56, v56
    v_exp_f32 v57, v57
    v_exp_f32 v58, v58
    v_smfmac_f32_32x32x32_bf16 v[80:95], v[176:179], v[48:55], v40
    buffer_load_dwordx4 v14, s[8:11], s73 offen offset:1024 lds
    v_exp_f32 v59, v59
    v_exp_f32 v60, v60
    v_exp_f32 v61, v61
    v_exp_f32 v62, v62
    v_exp_f32 v63, v63
    v_exp_f32 v64, v64
    v_exp_f32 v65, v65
    v_smfmac_f32_32x32x32_bf16 v[80:95], v[180:183], v[56:63], v40
    ds_read_b128 v[96:99], v38 offset:0
    v_exp_f32 v66, v66
    v_exp_f32 v67, v67
    v_exp_f32 v68, v68
    v_mfma_f32_32x32x16_bf16 v[48:63], v[136:139], v[216:219], 0
    ds_read_b128 v[100:103], v38 offset:1024
    v_exp_f32 v69, v69
    v_exp_f32 v70, v70
    v_exp_f32 v71, v71
    v_exp_f32 v72, v72
    v_exp_f32 v73, v73
    v_exp_f32 v74, v74
    v_smfmac_f32_32x32x32_bf16 v[80:95], v[184:187], v[64:71], v40
    ds_read_b32 v104, v39 offset:2048
    v_exp_f32 v75, v75
    v_exp_f32 v76, v76
    v_exp_f32 v77, v77
    v_exp_f32 v78, v78
    v_exp_f32 v79, v79
    v_exp_f32 v48, v48
    v_exp_f32 v49, v49
    v_smfmac_f32_32x32x32_bf16 v[80:95], v[188:191], v[72:79], v40
    buffer_load_dwordx4 v15, s[8:11], s73 offen offset:2048 lds
    v_exp_f32 v50, v50
    v_exp_f32 v51, v51
    v_exp_f32 v52, v52
    v_mfma_f32_32x32x16_bf16 v[64:79], v[140:143], v[216:219], 0
    buffer_load_dwordx4 v[248:251], v19, s[44:47], s80 offen offset:2048
    v_exp_f32 v53, v53
    v_exp_f32 v54, v54
    v_exp_f32 v55, v55
    v_exp_f32 v56, v56
    v_exp_f32 v57, v57
    v_exp_f32 v58, v58
    v_smfmac_f32_32x32x32_bf16 v[80:95], v[192:195], v[48:55], v40
    v_exp_f32 v59, v59
    v_exp_f32 v60, v60
    v_exp_f32 v61, v61
    v_exp_f32 v62, v62
    v_exp_f32 v63, v63
    v_exp_f32 v64, v64
    v_exp_f32 v65, v65
    v_smfmac_f32_32x32x32_bf16 v[80:95], v[196:199], v[56:63], v40
    buffer_load_dwordx4 v16, s[8:11], s73 offen offset:3072 lds
    v_exp_f32 v66, v66
    v_exp_f32 v67, v67
    v_exp_f32 v68, v68
    v_mfma_f32_32x32x16_bf16 v[48:63], v[112:115], v[220:223], 0
    s_add_u32 m0, s78, 65536
    v_exp_f32 v69, v69
    v_exp_f32 v70, v70
    v_exp_f32 v71, v71
    v_exp_f32 v72, v72
    v_exp_f32 v73, v73
    v_exp_f32 v74, v74
    v_smfmac_f32_32x32x32_bf16 v[80:95], v[200:203], v[64:71], v40
    buffer_load_dwordx4 v[252:255], v17, s[44:47], s81 offen offset:0
    v_exp_f32 v75, v75
    v_exp_f32 v76, v76
    v_exp_f32 v77, v77
    v_exp_f32 v78, v78
    v_exp_f32 v79, v79
    v_exp_f32 v48, v48
    v_exp_f32 v49, v49
    v_smfmac_f32_32x32x32_bf16 v[80:95], v[204:207], v[72:79], v40
    buffer_load_dwordx4 v17, s[44:47], s75 offen offset:0 lds
    v_exp_f32 v50, v50
    v_exp_f32 v51, v51
    v_exp_f32 v52, v52
    v_mfma_f32_32x32x16_bf16 v[64:79], v[116:119], v[220:223], 0
    s_waitcnt lgkmcnt(0)
    v_exp_f32 v53, v53
    v_exp_f32 v54, v54
    v_exp_f32 v55, v55
    v_exp_f32 v56, v56
    v_exp_f32 v57, v57
    v_exp_f32 v58, v58
    v_smfmac_f32_32x32x32_bf16 v[96:111], v[144:147], v[48:55], v40
    buffer_load_dwordx4 v[208:211], v18, s[44:47], s81 offen offset:1024
    v_exp_f32 v59, v59
    v_exp_f32 v60, v60
    v_exp_f32 v61, v61
    v_exp_f32 v62, v62
    v_exp_f32 v63, v63
    v_exp_f32 v64, v64
    v_exp_f32 v65, v65
    v_smfmac_f32_32x32x32_bf16 v[96:111], v[148:151], v[56:63], v40
    ds_write_b128 v34, v[80:83] offset:18432
    v_exp_f32 v66, v66
    v_exp_f32 v67, v67
    v_exp_f32 v68, v68
    v_mfma_f32_32x32x16_bf16 v[48:63], v[120:123], v[220:223], 0
    ds_write_b128 v34, v[84:87] offset:19456
    v_exp_f32 v69, v69
    v_exp_f32 v70, v70
    v_exp_f32 v71, v71
    v_exp_f32 v72, v72
    v_exp_f32 v73, v73
    v_exp_f32 v74, v74
    v_smfmac_f32_32x32x32_bf16 v[96:111], v[152:155], v[64:71], v40
    ds_write_b32 v35, v88 offset:20480
    v_exp_f32 v75, v75
    v_exp_f32 v76, v76
    v_exp_f32 v77, v77
    v_exp_f32 v78, v78
    v_exp_f32 v79, v79
    v_exp_f32 v48, v48
    v_exp_f32 v49, v49
    v_smfmac_f32_32x32x32_bf16 v[96:111], v[156:159], v[72:79], v40
    buffer_load_dwordx4 v18, s[44:47], s75 offen offset:1024 lds
    v_exp_f32 v50, v50
    v_exp_f32 v51, v51
    v_exp_f32 v52, v52
    v_mfma_f32_32x32x16_bf16 v[64:79], v[124:127], v[220:223], 0
    buffer_load_dwordx4 v[212:215], v19, s[44:47], s81 offen offset:2048
    v_exp_f32 v53, v53
    v_exp_f32 v54, v54
    v_exp_f32 v55, v55
    v_exp_f32 v56, v56
    v_exp_f32 v57, v57
    v_exp_f32 v58, v58
    v_smfmac_f32_32x32x32_bf16 v[96:111], v[160:163], v[48:55], v40
    v_exp_f32 v59, v59
    v_exp_f32 v60, v60
    v_exp_f32 v61, v61
    v_exp_f32 v62, v62
    v_exp_f32 v63, v63
    v_exp_f32 v64, v64
    v_exp_f32 v65, v65
    v_smfmac_f32_32x32x32_bf16 v[96:111], v[164:167], v[56:63], v40
    buffer_load_dwordx4 v19, s[44:47], s75 offen offset:2048 lds
    v_exp_f32 v66, v66
    v_exp_f32 v67, v67
    v_exp_f32 v68, v68
    v_mfma_f32_32x32x16_bf16 v[48:63], v[128:131], v[220:223], 0
    s_add_u32 m0, s78, 90112
    v_exp_f32 v69, v69
    v_exp_f32 v70, v70
    v_exp_f32 v71, v71
    v_exp_f32 v72, v72
    v_exp_f32 v73, v73
    v_exp_f32 v74, v74
    v_smfmac_f32_32x32x32_bf16 v[96:111], v[168:171], v[64:71], v40
    v_exp_f32 v75, v75
    v_exp_f32 v76, v76
    v_exp_f32 v77, v77
    v_exp_f32 v78, v78
    v_exp_f32 v79, v79
    v_exp_f32 v48, v48
    v_exp_f32 v49, v49
    v_smfmac_f32_32x32x32_bf16 v[96:111], v[172:175], v[72:79], v40
    s_waitcnt lgkmcnt(0)
    v_exp_f32 v50, v50
    v_exp_f32 v51, v51
    v_exp_f32 v52, v52
    v_mfma_f32_32x32x16_bf16 v[64:79], v[132:135], v[220:223], 0
    s_barrier
    v_exp_f32 v53, v53
    v_exp_f32 v54, v54
    v_exp_f32 v55, v55
    v_exp_f32 v56, v56
    v_exp_f32 v57, v57
    v_exp_f32 v58, v58
    v_smfmac_f32_32x32x32_bf16 v[96:111], v[176:179], v[48:55], v40
    buffer_load_dwordx4 v17, s[44:47], s76 offen offset:0 lds
    v_exp_f32 v59, v59
    v_exp_f32 v60, v60
    v_exp_f32 v61, v61
    v_exp_f32 v62, v62
    v_exp_f32 v63, v63
    v_exp_f32 v64, v64
    v_exp_f32 v65, v65
    v_smfmac_f32_32x32x32_bf16 v[96:111], v[180:183], v[56:63], v40
    ds_read_b128 v[80:83], v38 offset:18432
    v_exp_f32 v66, v66
    v_exp_f32 v67, v67
    v_exp_f32 v68, v68
    v_mfma_f32_32x32x16_bf16 v[48:63], v[136:139], v[220:223], 0
    ds_read_b128 v[84:87], v38 offset:19456
    v_exp_f32 v69, v69
    v_exp_f32 v70, v70
    v_exp_f32 v71, v71
    v_exp_f32 v72, v72
    v_exp_f32 v73, v73
    v_exp_f32 v74, v74
    v_smfmac_f32_32x32x32_bf16 v[96:111], v[184:187], v[64:71], v40
    ds_read_b32 v88, v39 offset:20480
    v_exp_f32 v75, v75
    v_exp_f32 v76, v76
    v_exp_f32 v77, v77
    v_exp_f32 v78, v78
    v_exp_f32 v79, v79
    v_exp_f32 v48, v48
    v_exp_f32 v49, v49
    v_smfmac_f32_32x32x32_bf16 v[96:111], v[188:191], v[72:79], v40
    buffer_load_dwordx4 v18, s[44:47], s76 offen offset:1024 lds
    v_exp_f32 v50, v50
    v_exp_f32 v51, v51
    v_exp_f32 v52, v52
    v_mfma_f32_32x32x16_bf16 v[64:79], v[140:143], v[220:223], 0
    buffer_load_dwordx4 v[216:219], v17, s[44:47], s82 offen offset:0
    v_exp_f32 v53, v53
    v_exp_f32 v54, v54
    v_exp_f32 v55, v55
    v_exp_f32 v56, v56
    v_exp_f32 v57, v57
    v_exp_f32 v58, v58
    v_smfmac_f32_32x32x32_bf16 v[96:111], v[192:195], v[48:55], v40
    v_exp_f32 v59, v59
    v_exp_f32 v60, v60
    v_exp_f32 v61, v61
    v_exp_f32 v62, v62
    v_exp_f32 v63, v63
    v_exp_f32 v64, v64
    v_exp_f32 v65, v65
    v_smfmac_f32_32x32x32_bf16 v[96:111], v[196:199], v[56:63], v40
    buffer_load_dwordx4 v19, s[44:47], s76 offen offset:2048 lds
    v_exp_f32 v66, v66
    v_exp_f32 v67, v67
    v_exp_f32 v68, v68
    v_mfma_f32_32x32x16_bf16 v[48:63], v[112:115], v[224:227], 0
    s_mov_b32 m0, s79
    v_exp_f32 v69, v69
    v_exp_f32 v70, v70
    v_exp_f32 v71, v71
    v_exp_f32 v72, v72
    v_exp_f32 v73, v73
    v_exp_f32 v74, v74
    v_smfmac_f32_32x32x32_bf16 v[96:111], v[200:203], v[64:71], v40
    v_exp_f32 v75, v75
    v_exp_f32 v76, v76
    v_exp_f32 v77, v77
    v_exp_f32 v78, v78
    v_exp_f32 v79, v79
    v_exp_f32 v48, v48
    v_exp_f32 v49, v49
    v_smfmac_f32_32x32x32_bf16 v[96:111], v[204:207], v[72:79], v40
    buffer_load_dwordx4 v17, s[44:47], s77 offen offset:0 lds
    v_exp_f32 v50, v50
    v_exp_f32 v51, v51
    v_exp_f32 v52, v52
    v_mfma_f32_32x32x16_bf16 v[64:79], v[116:119], v[224:227], 0
    s_waitcnt lgkmcnt(0)
    v_exp_f32 v53, v53
    v_exp_f32 v54, v54
    v_exp_f32 v55, v55
    v_exp_f32 v56, v56
    v_exp_f32 v57, v57
    v_exp_f32 v58, v58
    v_smfmac_f32_32x32x32_bf16 v[80:95], v[144:147], v[48:55], v40
    buffer_load_dwordx4 v[220:223], v18, s[44:47], s82 offen offset:1024
    v_exp_f32 v59, v59
    v_exp_f32 v60, v60
    v_exp_f32 v61, v61
    v_exp_f32 v62, v62
    v_exp_f32 v63, v63
    v_exp_f32 v64, v64
    v_exp_f32 v65, v65
    v_smfmac_f32_32x32x32_bf16 v[80:95], v[148:151], v[56:63], v40
    ds_write_b128 v34, v[96:99] offset:0
    v_exp_f32 v66, v66
    v_exp_f32 v67, v67
    v_exp_f32 v68, v68
    v_mfma_f32_32x32x16_bf16 v[48:63], v[120:123], v[224:227], 0
    ds_write_b128 v34, v[100:103] offset:1024
    v_exp_f32 v69, v69
    v_exp_f32 v70, v70
    v_exp_f32 v71, v71
    v_exp_f32 v72, v72
    v_exp_f32 v73, v73
    v_exp_f32 v74, v74
    v_smfmac_f32_32x32x32_bf16 v[80:95], v[152:155], v[64:71], v40
    ds_write_b32 v35, v104 offset:2048
    v_exp_f32 v75, v75
    v_exp_f32 v76, v76
    v_exp_f32 v77, v77
    v_exp_f32 v78, v78
    v_exp_f32 v79, v79
    v_exp_f32 v48, v48
    v_exp_f32 v49, v49
    v_smfmac_f32_32x32x32_bf16 v[80:95], v[156:159], v[72:79], v40
    buffer_load_dwordx4 v18, s[44:47], s77 offen offset:1024 lds
    v_exp_f32 v50, v50
    v_exp_f32 v51, v51
    v_exp_f32 v52, v52
    v_mfma_f32_32x32x16_bf16 v[64:79], v[124:127], v[224:227], 0
    v_exp_f32 v53, v53
    v_exp_f32 v54, v54
    v_exp_f32 v55, v55
    v_exp_f32 v56, v56
    v_exp_f32 v57, v57
    v_exp_f32 v58, v58
    v_smfmac_f32_32x32x32_bf16 v[80:95], v[160:163], v[48:55], v40
    v_exp_f32 v59, v59
    v_exp_f32 v60, v60
    v_exp_f32 v61, v61
    v_exp_f32 v62, v62
    v_exp_f32 v63, v63
    v_exp_f32 v64, v64
    v_exp_f32 v65, v65
    v_smfmac_f32_32x32x32_bf16 v[80:95], v[164:167], v[56:63], v40
    buffer_load_dwordx4 v19, s[44:47], s77 offen offset:2048 lds
    v_exp_f32 v66, v66
    v_exp_f32 v67, v67
    v_exp_f32 v68, v68
    v_mfma_f32_32x32x16_bf16 v[48:63], v[128:131], v[224:227], 0
    v_exp_f32 v69, v69
    v_exp_f32 v70, v70
    v_exp_f32 v71, v71
    v_exp_f32 v72, v72
    v_exp_f32 v73, v73
    v_exp_f32 v74, v74
    v_smfmac_f32_32x32x32_bf16 v[80:95], v[168:171], v[64:71], v40
    v_exp_f32 v75, v75
    v_exp_f32 v76, v76
    v_exp_f32 v77, v77
    v_exp_f32 v78, v78
    v_exp_f32 v79, v79
    v_exp_f32 v48, v48
    v_exp_f32 v49, v49
    v_smfmac_f32_32x32x32_bf16 v[80:95], v[172:175], v[72:79], v40
    s_waitcnt lgkmcnt(0)
    v_exp_f32 v50, v50
    v_exp_f32 v51, v51
    v_exp_f32 v52, v52
    v_mfma_f32_32x32x16_bf16 v[64:79], v[132:135], v[224:227], 0
    s_barrier
    v_exp_f32 v53, v53
    v_exp_f32 v54, v54
    v_exp_f32 v55, v55
    v_exp_f32 v56, v56
    v_exp_f32 v57, v57
    v_exp_f32 v58, v58
    v_smfmac_f32_32x32x32_bf16 v[80:95], v[176:179], v[48:55], v40
    buffer_load_dword v43, v41, s[52:55], s84 offen
    v_exp_f32 v59, v59
    v_exp_f32 v60, v60
    v_exp_f32 v61, v61
    v_exp_f32 v62, v62
    v_exp_f32 v63, v63
    v_exp_f32 v64, v64
    v_exp_f32 v65, v65
    v_smfmac_f32_32x32x32_bf16 v[80:95], v[180:183], v[56:63], v40
    ds_read_b128 v[96:99], v38 offset:0
    v_exp_f32 v66, v66
    v_exp_f32 v67, v67
    v_exp_f32 v68, v68
    v_mfma_f32_32x32x16_bf16 v[48:63], v[136:139], v[224:227], 0
    ds_read_b128 v[100:103], v38 offset:1024
    v_exp_f32 v69, v69
    v_exp_f32 v70, v70
    v_exp_f32 v71, v71
    v_exp_f32 v72, v72
    v_exp_f32 v73, v73
    v_exp_f32 v74, v74
    v_smfmac_f32_32x32x32_bf16 v[80:95], v[184:187], v[64:71], v40
    ds_read_b32 v104, v39 offset:2048
    v_exp_f32 v75, v75
    v_exp_f32 v76, v76
    v_exp_f32 v77, v77
    v_exp_f32 v78, v78
    v_exp_f32 v79, v79
    v_exp_f32 v48, v48
    v_exp_f32 v49, v49
    v_smfmac_f32_32x32x32_bf16 v[80:95], v[188:191], v[72:79], v40
    v_exp_f32 v50, v50
    v_exp_f32 v51, v51
    v_exp_f32 v52, v52
    v_mfma_f32_32x32x16_bf16 v[64:79], v[140:143], v[224:227], 0
    v_exp_f32 v53, v53
    v_exp_f32 v54, v54
    v_exp_f32 v55, v55
    v_exp_f32 v56, v56
    v_exp_f32 v57, v57
    v_exp_f32 v58, v58
    v_smfmac_f32_32x32x32_bf16 v[80:95], v[192:195], v[48:55], v40
    v_exp_f32 v59, v59
    v_exp_f32 v60, v60
    v_exp_f32 v61, v61
    v_exp_f32 v62, v62
    v_exp_f32 v63, v63
    v_exp_f32 v64, v64
    v_exp_f32 v65, v65
    v_smfmac_f32_32x32x32_bf16 v[80:95], v[196:199], v[56:63], v40
    v_exp_f32 v66, v66
    v_exp_f32 v67, v67
    v_exp_f32 v68, v68
    v_mfma_f32_32x32x16_bf16 v[48:63], v[112:115], v[228:231], 0
    v_exp_f32 v69, v69
    v_exp_f32 v70, v70
    v_exp_f32 v71, v71
    v_exp_f32 v72, v72
    v_exp_f32 v73, v73
    v_exp_f32 v74, v74
    v_smfmac_f32_32x32x32_bf16 v[80:95], v[200:203], v[64:71], v40
    v_exp_f32 v75, v75
    v_exp_f32 v76, v76
    v_exp_f32 v77, v77
    v_exp_f32 v78, v78
    v_exp_f32 v79, v79
    v_exp_f32 v48, v48
    v_exp_f32 v49, v49
    v_smfmac_f32_32x32x32_bf16 v[80:95], v[204:207], v[72:79], v40
    buffer_load_dwordx4 v[224:227], v19, s[44:47], s82 offen offset:2048
    v_exp_f32 v50, v50
    v_exp_f32 v51, v51
    v_exp_f32 v52, v52
    v_mfma_f32_32x32x16_bf16 v[64:79], v[116:119], v[228:231], 0
    s_waitcnt lgkmcnt(0)
    v_exp_f32 v53, v53
    v_exp_f32 v54, v54
    v_exp_f32 v55, v55
    v_exp_f32 v56, v56
    v_exp_f32 v57, v57
    v_exp_f32 v58, v58
    v_smfmac_f32_32x32x32_bf16 v[96:111], v[144:147], v[48:55], v40
    v_exp_f32 v59, v59
    v_exp_f32 v60, v60
    v_exp_f32 v61, v61
    v_exp_f32 v62, v62
    v_exp_f32 v63, v63
    v_exp_f32 v64, v64
    v_exp_f32 v65, v65
    v_smfmac_f32_32x32x32_bf16 v[96:111], v[148:151], v[56:63], v40
    ds_write_b128 v34, v[80:83] offset:18432
    v_exp_f32 v66, v66
    v_exp_f32 v67, v67
    v_exp_f32 v68, v68
    v_mfma_f32_32x32x16_bf16 v[48:63], v[120:123], v[228:231], 0
    ds_write_b128 v34, v[84:87] offset:19456
    v_exp_f32 v69, v69
    v_exp_f32 v70, v70
    v_exp_f32 v71, v71
    v_exp_f32 v72, v72
    v_exp_f32 v73, v73
    v_exp_f32 v74, v74
    v_smfmac_f32_32x32x32_bf16 v[96:111], v[152:155], v[64:71], v40
    ds_write_b32 v35, v88 offset:20480
    v_exp_f32 v75, v75
    v_exp_f32 v76, v76
    v_exp_f32 v77, v77
    v_exp_f32 v78, v78
    v_exp_f32 v79, v79
    v_exp_f32 v48, v48
    v_exp_f32 v49, v49
    v_smfmac_f32_32x32x32_bf16 v[96:111], v[156:159], v[72:79], v40
    buffer_load_dword v43, v41, s[48:51], s83 offen
    v_exp_f32 v50, v50
    v_exp_f32 v51, v51
    v_exp_f32 v52, v52
    v_mfma_f32_32x32x16_bf16 v[64:79], v[124:127], v[228:231], 0
    v_exp_f32 v53, v53
    v_exp_f32 v54, v54
    v_exp_f32 v55, v55
    v_exp_f32 v56, v56
    v_exp_f32 v57, v57
    v_exp_f32 v58, v58
    v_smfmac_f32_32x32x32_bf16 v[96:111], v[160:163], v[48:55], v40
    v_exp_f32 v59, v59
    v_exp_f32 v60, v60
    v_exp_f32 v61, v61
    v_exp_f32 v62, v62
    v_exp_f32 v63, v63
    v_exp_f32 v64, v64
    v_exp_f32 v65, v65
    v_smfmac_f32_32x32x32_bf16 v[96:111], v[164:167], v[56:63], v40
    v_exp_f32 v66, v66
    v_exp_f32 v67, v67
    v_exp_f32 v68, v68
    v_mfma_f32_32x32x16_bf16 v[48:63], v[128:131], v[228:231], 0
    v_exp_f32 v69, v69
    v_exp_f32 v70, v70
    v_exp_f32 v71, v71
    v_exp_f32 v72, v72
    v_exp_f32 v73, v73
    v_exp_f32 v74, v74
    v_smfmac_f32_32x32x32_bf16 v[96:111], v[168:171], v[64:71], v40
    v_exp_f32 v75, v75
    v_exp_f32 v76, v76
    v_exp_f32 v77, v77
    v_exp_f32 v78, v78
    v_exp_f32 v79, v79
    v_exp_f32 v48, v48
    v_exp_f32 v49, v49
    v_smfmac_f32_32x32x32_bf16 v[96:111], v[172:175], v[72:79], v40
    s_waitcnt lgkmcnt(0)
    v_exp_f32 v50, v50
    v_exp_f32 v51, v51
    v_exp_f32 v52, v52
    v_mfma_f32_32x32x16_bf16 v[64:79], v[132:135], v[228:231], 0
    s_barrier
    v_exp_f32 v53, v53
    v_exp_f32 v54, v54
    v_exp_f32 v55, v55
    v_exp_f32 v56, v56
    v_exp_f32 v57, v57
    v_exp_f32 v58, v58
    v_smfmac_f32_32x32x32_bf16 v[96:111], v[176:179], v[48:55], v40
    v_exp_f32 v59, v59
    v_exp_f32 v60, v60
    v_exp_f32 v61, v61
    v_exp_f32 v62, v62
    v_exp_f32 v63, v63
    v_exp_f32 v64, v64
    v_exp_f32 v65, v65
    v_smfmac_f32_32x32x32_bf16 v[96:111], v[180:183], v[56:63], v40
    ds_read_b128 v[80:83], v38 offset:18432
    v_exp_f32 v66, v66
    v_exp_f32 v67, v67
    v_exp_f32 v68, v68
    v_mfma_f32_32x32x16_bf16 v[48:63], v[136:139], v[228:231], 0
    ds_read_b128 v[84:87], v38 offset:19456
    v_exp_f32 v69, v69
    v_exp_f32 v70, v70
    v_exp_f32 v71, v71
    v_exp_f32 v72, v72
    v_exp_f32 v73, v73
    v_exp_f32 v74, v74
    v_smfmac_f32_32x32x32_bf16 v[96:111], v[184:187], v[64:71], v40
    ds_read_b32 v88, v39 offset:20480
    v_exp_f32 v75, v75
    v_exp_f32 v76, v76
    v_exp_f32 v77, v77
    v_exp_f32 v78, v78
    v_exp_f32 v79, v79
    v_exp_f32 v48, v48
    v_exp_f32 v49, v49
    v_smfmac_f32_32x32x32_bf16 v[96:111], v[188:191], v[72:79], v40
    v_exp_f32 v50, v50
    v_exp_f32 v51, v51
    v_exp_f32 v52, v52
    v_mfma_f32_32x32x16_bf16 v[64:79], v[140:143], v[228:231], 0
    v_exp_f32 v53, v53
    v_exp_f32 v54, v54
    v_exp_f32 v55, v55
    v_exp_f32 v56, v56
    v_exp_f32 v57, v57
    v_exp_f32 v58, v58
    v_smfmac_f32_32x32x32_bf16 v[96:111], v[192:195], v[48:55], v40
    v_exp_f32 v59, v59
    v_exp_f32 v60, v60
    v_exp_f32 v61, v61
    v_exp_f32 v62, v62
    v_exp_f32 v63, v63
    v_exp_f32 v64, v64
    v_exp_f32 v65, v65
    v_smfmac_f32_32x32x32_bf16 v[96:111], v[196:199], v[56:63], v40
    buffer_load_dword v43, v33, s[12:15], 0 offen
    v_exp_f32 v66, v66
    v_exp_f32 v67, v67
    v_exp_f32 v68, v68
    v_mfma_f32_32x32x16_bf16 v[48:63], v[112:115], v[232:235], 0
    v_exp_f32 v69, v69
    v_exp_f32 v70, v70
    v_exp_f32 v71, v71
    v_exp_f32 v72, v72
    v_exp_f32 v73, v73
    v_exp_f32 v74, v74
    v_smfmac_f32_32x32x32_bf16 v[96:111], v[200:203], v[64:71], v40
    v_exp_f32 v75, v75
    v_exp_f32 v76, v76
    v_exp_f32 v77, v77
    v_exp_f32 v78, v78
    v_exp_f32 v79, v79
    v_exp_f32 v48, v48
    v_exp_f32 v49, v49
    v_smfmac_f32_32x32x32_bf16 v[96:111], v[204:207], v[72:79], v40
    v_exp_f32 v50, v50
    v_exp_f32 v51, v51
    v_exp_f32 v52, v52
    v_mfma_f32_32x32x16_bf16 v[64:79], v[116:119], v[232:235], 0
    s_waitcnt lgkmcnt(0)
    v_exp_f32 v53, v53
    v_exp_f32 v54, v54
    v_exp_f32 v55, v55
    v_exp_f32 v56, v56
    v_exp_f32 v57, v57
    v_exp_f32 v58, v58
    v_smfmac_f32_32x32x32_bf16 v[80:95], v[144:147], v[48:55], v40
    v_exp_f32 v59, v59
    v_exp_f32 v60, v60
    v_exp_f32 v61, v61
    v_exp_f32 v62, v62
    v_exp_f32 v63, v63
    v_exp_f32 v64, v64
    v_exp_f32 v65, v65
    v_smfmac_f32_32x32x32_bf16 v[80:95], v[148:151], v[56:63], v40
    ds_write_b128 v34, v[96:99] offset:0
    v_exp_f32 v66, v66
    v_exp_f32 v67, v67
    v_exp_f32 v68, v68
    v_mfma_f32_32x32x16_bf16 v[48:63], v[120:123], v[232:235], 0
    ds_write_b128 v34, v[100:103] offset:1024
    v_exp_f32 v69, v69
    v_exp_f32 v70, v70
    v_exp_f32 v71, v71
    v_exp_f32 v72, v72
    v_exp_f32 v73, v73
    v_exp_f32 v74, v74
    v_smfmac_f32_32x32x32_bf16 v[80:95], v[152:155], v[64:71], v40
    ds_write_b32 v35, v104 offset:2048
    v_exp_f32 v75, v75
    v_exp_f32 v76, v76
    v_exp_f32 v77, v77
    v_exp_f32 v78, v78
    v_exp_f32 v79, v79
    v_exp_f32 v48, v48
    v_exp_f32 v49, v49
    v_smfmac_f32_32x32x32_bf16 v[80:95], v[156:159], v[72:79], v40
    v_exp_f32 v50, v50
    v_exp_f32 v51, v51
    v_exp_f32 v52, v52
    v_mfma_f32_32x32x16_bf16 v[64:79], v[124:127], v[232:235], 0
    v_exp_f32 v53, v53
    v_exp_f32 v54, v54
    v_exp_f32 v55, v55
    v_exp_f32 v56, v56
    v_exp_f32 v57, v57
    v_exp_f32 v58, v58
    v_smfmac_f32_32x32x32_bf16 v[80:95], v[160:163], v[48:55], v40
    v_exp_f32 v59, v59
    v_exp_f32 v60, v60
    v_exp_f32 v61, v61
    v_exp_f32 v62, v62
    v_exp_f32 v63, v63
    v_exp_f32 v64, v64
    v_exp_f32 v65, v65
    v_smfmac_f32_32x32x32_bf16 v[80:95], v[164:167], v[56:63], v40
    v_exp_f32 v66, v66
    v_exp_f32 v67, v67
    v_exp_f32 v68, v68
    v_mfma_f32_32x32x16_bf16 v[48:63], v[128:131], v[232:235], 0
    v_exp_f32 v69, v69
    v_exp_f32 v70, v70
    v_exp_f32 v71, v71
    v_exp_f32 v72, v72
    v_exp_f32 v73, v73
    v_exp_f32 v74, v74
    v_smfmac_f32_32x32x32_bf16 v[80:95], v[168:171], v[64:71], v40
    v_exp_f32 v75, v75
    v_exp_f32 v76, v76
    v_exp_f32 v77, v77
    v_exp_f32 v78, v78
    v_exp_f32 v79, v79
    v_exp_f32 v48, v48
    v_exp_f32 v49, v49
    v_smfmac_f32_32x32x32_bf16 v[80:95], v[172:175], v[72:79], v40
    s_waitcnt lgkmcnt(0)
    v_exp_f32 v50, v50
    v_exp_f32 v51, v51
    v_exp_f32 v52, v52
    v_mfma_f32_32x32x16_bf16 v[64:79], v[132:135], v[232:235], 0
    s_barrier
    v_exp_f32 v53, v53
    v_exp_f32 v54, v54
    v_exp_f32 v55, v55
    v_exp_f32 v56, v56
    v_exp_f32 v57, v57
    v_exp_f32 v58, v58
    v_smfmac_f32_32x32x32_bf16 v[80:95], v[176:179], v[48:55], v40
    global_load_dword v43, v[44:45], off
    v_exp_f32 v59, v59
    v_exp_f32 v60, v60
    v_exp_f32 v61, v61
    v_exp_f32 v62, v62
    v_exp_f32 v63, v63
    v_exp_f32 v64, v64
    v_exp_f32 v65, v65
    v_smfmac_f32_32x32x32_bf16 v[80:95], v[180:183], v[56:63], v40
    ds_read_b128 v[96:99], v38 offset:0
    v_exp_f32 v66, v66
    v_exp_f32 v67, v67
    v_exp_f32 v68, v68
    v_mfma_f32_32x32x16_bf16 v[48:63], v[136:139], v[232:235], 0
    ds_read_b128 v[100:103], v38 offset:1024
    v_exp_f32 v69, v69
    v_exp_f32 v70, v70
    v_exp_f32 v71, v71
    v_exp_f32 v72, v72
    v_exp_f32 v73, v73
    v_exp_f32 v74, v74
    v_smfmac_f32_32x32x32_bf16 v[80:95], v[184:187], v[64:71], v40
    ds_read_b32 v104, v39 offset:2048
    v_exp_f32 v75, v75
    v_exp_f32 v76, v76
    v_exp_f32 v77, v77
    v_exp_f32 v78, v78
    v_exp_f32 v79, v79
    v_exp_f32 v48, v48
    v_exp_f32 v49, v49
    v_smfmac_f32_32x32x32_bf16 v[80:95], v[188:191], v[72:79], v40
    buffer_load_dword v9, v42, s[12:15], s88 offen offset:768 sc1
    v_exp_f32 v50, v50
    v_exp_f32 v51, v51
    v_exp_f32 v52, v52
    v_mfma_f32_32x32x16_bf16 v[64:79], v[140:143], v[232:235], 0
    v_exp_f32 v53, v53
    v_exp_f32 v54, v54
    v_exp_f32 v55, v55
    v_exp_f32 v56, v56
    v_exp_f32 v57, v57
    v_exp_f32 v58, v58
    v_smfmac_f32_32x32x32_bf16 v[80:95], v[192:195], v[48:55], v40
    v_exp_f32 v59, v59
    v_exp_f32 v60, v60
    v_exp_f32 v61, v61
    v_exp_f32 v62, v62
    v_exp_f32 v63, v63
    v_exp_f32 v64, v64
    v_exp_f32 v65, v65
    v_smfmac_f32_32x32x32_bf16 v[80:95], v[196:199], v[56:63], v40
    v_exp_f32 v66, v66
    v_exp_f32 v67, v67
    v_exp_f32 v68, v68
    v_mfma_f32_32x32x16_bf16 v[48:63], v[112:115], v[236:239], 0
    v_exp_f32 v69, v69
    v_exp_f32 v70, v70
    v_exp_f32 v71, v71
    v_exp_f32 v72, v72
    v_exp_f32 v73, v73
    v_exp_f32 v74, v74
    v_smfmac_f32_32x32x32_bf16 v[80:95], v[200:203], v[64:71], v40
    v_exp_f32 v75, v75
    v_exp_f32 v76, v76
    v_exp_f32 v77, v77
    v_exp_f32 v78, v78
    v_exp_f32 v79, v79
    v_exp_f32 v48, v48
    v_exp_f32 v49, v49
    v_smfmac_f32_32x32x32_bf16 v[80:95], v[204:207], v[72:79], v40
    v_exp_f32 v50, v50
    v_exp_f32 v51, v51
    v_exp_f32 v52, v52
    v_mfma_f32_32x32x16_bf16 v[64:79], v[116:119], v[236:239], 0
    s_waitcnt lgkmcnt(0)
    v_exp_f32 v53, v53
    v_exp_f32 v54, v54
    v_exp_f32 v55, v55
    v_exp_f32 v56, v56
    v_exp_f32 v57, v57
    v_exp_f32 v58, v58
    v_smfmac_f32_32x32x32_bf16 v[96:111], v[144:147], v[48:55], v40
    v_exp_f32 v59, v59
    v_exp_f32 v60, v60
    v_exp_f32 v61, v61
    v_exp_f32 v62, v62
    v_exp_f32 v63, v63
    v_exp_f32 v64, v64
    v_exp_f32 v65, v65
    v_smfmac_f32_32x32x32_bf16 v[96:111], v[148:151], v[56:63], v40
    ds_write_b128 v34, v[80:83] offset:18432
    v_exp_f32 v66, v66
    v_exp_f32 v67, v67
    v_exp_f32 v68, v68
    v_mfma_f32_32x32x16_bf16 v[48:63], v[120:123], v[236:239], 0
    ds_write_b128 v34, v[84:87] offset:19456
    v_exp_f32 v69, v69
    v_exp_f32 v70, v70
    v_exp_f32 v71, v71
    v_exp_f32 v72, v72
    v_exp_f32 v73, v73
    v_exp_f32 v74, v74
    v_smfmac_f32_32x32x32_bf16 v[96:111], v[152:155], v[64:71], v40
    ds_write_b32 v35, v88 offset:20480
    v_exp_f32 v75, v75
    v_exp_f32 v76, v76
    v_exp_f32 v77, v77
    v_exp_f32 v78, v78
    v_exp_f32 v79, v79
    v_exp_f32 v48, v48
    v_exp_f32 v49, v49
    v_smfmac_f32_32x32x32_bf16 v[96:111], v[156:159], v[72:79], v40
    v_exp_f32 v50, v50
    v_exp_f32 v51, v51
    v_exp_f32 v52, v52
    v_mfma_f32_32x32x16_bf16 v[64:79], v[124:127], v[236:239], 0
    v_exp_f32 v53, v53
    v_exp_f32 v54, v54
    v_exp_f32 v55, v55
    v_exp_f32 v56, v56
    v_exp_f32 v57, v57
    v_exp_f32 v58, v58
    v_smfmac_f32_32x32x32_bf16 v[96:111], v[160:163], v[48:55], v40
    v_exp_f32 v59, v59
    v_exp_f32 v60, v60
    v_exp_f32 v61, v61
    v_exp_f32 v62, v62
    v_exp_f32 v63, v63
    v_exp_f32 v64, v64
    v_exp_f32 v65, v65
    v_smfmac_f32_32x32x32_bf16 v[96:111], v[164:167], v[56:63], v40
    v_exp_f32 v66, v66
    v_exp_f32 v67, v67
    v_exp_f32 v68, v68
    v_mfma_f32_32x32x16_bf16 v[48:63], v[128:131], v[236:239], 0
    v_exp_f32 v69, v69
    v_exp_f32 v70, v70
    v_exp_f32 v71, v71
    v_exp_f32 v72, v72
    v_exp_f32 v73, v73
    v_exp_f32 v74, v74
    v_smfmac_f32_32x32x32_bf16 v[96:111], v[168:171], v[64:71], v40
    v_exp_f32 v75, v75
    v_exp_f32 v76, v76
    v_exp_f32 v77, v77
    v_exp_f32 v78, v78
    v_exp_f32 v79, v79
    v_exp_f32 v48, v48
    v_exp_f32 v49, v49
    v_smfmac_f32_32x32x32_bf16 v[96:111], v[172:175], v[72:79], v40
    s_waitcnt lgkmcnt(0) vmcnt(0)
    v_exp_f32 v50, v50
    v_exp_f32 v51, v51
    v_exp_f32 v52, v52
    v_mfma_f32_32x32x16_bf16 v[64:79], v[132:135], v[236:239], 0
    s_barrier
    v_exp_f32 v53, v53
    v_exp_f32 v54, v54
    v_exp_f32 v55, v55
    v_exp_f32 v56, v56
    v_exp_f32 v57, v57
    v_exp_f32 v58, v58
    v_smfmac_f32_32x32x32_bf16 v[96:111], v[176:179], v[48:55], v40
    v_exp_f32 v59, v59
    v_exp_f32 v60, v60
    v_exp_f32 v61, v61
    v_exp_f32 v62, v62
    v_exp_f32 v63, v63
    v_exp_f32 v64, v64
    v_exp_f32 v65, v65
    v_smfmac_f32_32x32x32_bf16 v[96:111], v[180:183], v[56:63], v40
    ds_read_b128 v[112:115], v36 offset:18432
    v_exp_f32 v66, v66
    v_exp_f32 v67, v67
    v_exp_f32 v68, v68
    v_mfma_f32_32x32x16_bf16 v[48:63], v[136:139], v[236:239], 0
    ds_read_b128 v[116:119], v36 offset:19456
    v_exp_f32 v69, v69
    v_exp_f32 v70, v70
    v_exp_f32 v71, v71
    v_exp_f32 v72, v72
    v_exp_f32 v73, v73
    v_exp_f32 v74, v74
    v_smfmac_f32_32x32x32_bf16 v[96:111], v[184:187], v[64:71], v40
    ds_read_b32 v120, v37 offset:20480
    v_exp_f32 v75, v75
    v_exp_f32 v76, v76
    v_exp_f32 v77, v77
    v_exp_f32 v78, v78
    v_exp_f32 v79, v79
    v_exp_f32 v48, v48
    v_exp_f32 v49, v49
    v_smfmac_f32_32x32x32_bf16 v[96:111], v[188:191], v[72:79], v40
    v_exp_f32 v50, v50
    v_exp_f32 v51, v51
    v_exp_f32 v52, v52
    v_mfma_f32_32x32x16_bf16 v[64:79], v[140:143], v[236:239], 0
    v_exp_f32 v53, v53
    v_exp_f32 v54, v54
    v_exp_f32 v55, v55
    v_exp_f32 v56, v56
    v_exp_f32 v57, v57
    v_exp_f32 v58, v58
    v_smfmac_f32_32x32x32_bf16 v[96:111], v[192:195], v[48:55], v40
    v_exp_f32 v59, v59
    v_exp_f32 v60, v60
    v_exp_f32 v61, v61
    v_exp_f32 v62, v62
    v_exp_f32 v63, v63
    v_exp_f32 v64, v64
    v_exp_f32 v65, v65
    v_smfmac_f32_32x32x32_bf16 v[96:111], v[196:199], v[56:63], v40
    v_exp_f32 v66, v66
    v_exp_f32 v67, v67
    v_exp_f32 v68, v68
    v_exp_f32 v69, v69
    v_exp_f32 v70, v70
    v_exp_f32 v71, v71
    v_exp_f32 v72, v72
    v_exp_f32 v73, v73
    v_exp_f32 v74, v74
    v_smfmac_f32_32x32x32_bf16 v[96:111], v[200:203], v[64:71], v40
    v_exp_f32 v75, v75
    v_exp_f32 v76, v76
    v_exp_f32 v77, v77
    v_exp_f32 v78, v78
    v_exp_f32 v79, v79
    s_mov_b32 s26, 0x27800000
    s_mov_b32 s27, 0x71800000
    v_smfmac_f32_32x32x32_bf16 v[96:111], v[204:207], v[72:79], v40
    s_mov_b32 s28, 0x7e800000
    s_lshl_b32 s5, s41, 3
    s_add_u32 s5, s5, s18
    s_lshl_b32 s5, s5, 5
    s_add_u32 s5, s5, s40
    s_lshl_b32 s20, s5, 10
    s_add_u32 s20, s20, 0x800000
    s_lshl_b32 s21, s5, 7
    s_add_u32 s21, s21, s43
    s_waitcnt lgkmcnt(0)
    s_nop 1
    v_add_f32 v104, v104, v120
    v_add_f32 v96, v96, v112
    v_add_f32 v97, v97, v113
    v_add_f32 v98, v98, v114
    v_add_f32 v99, v99, v115
    v_add_f32 v100, v100, v116
    v_add_f32 v101, v101, v117
    v_add_f32 v102, v102, v118
    v_add_f32 v103, v103, v119
ac_fin:
    v_rcp_f32 v4, v104
    v_cmp_nle_f32 s[30:31], s26, v104
    v_mul_f32 v48, v4, v96
    v_mul_f32 v49, v4, v97
    v_mul_f32 v50, v4, v98
    v_mul_f32 v51, v4, v99
    v_mul_f32 v52, v4, v100
    v_mul_f32 v53, v4, v101
    v_mul_f32 v54, v4, v102
    v_mul_f32 v55, v4, v103
    v_cvt_pk_bf16_f32 v108, v48, v49
    v_cvt_pk_bf16_f32 v109, v50, v51
    v_cvt_pk_bf16_f32 v110, v52, v53
    v_cvt_pk_bf16_f32 v111, v54, v55
    buffer_store_dwordx4 v[108:111], v7, s[12:15], s20 offen sc1
    v_cmp_nge_f32 s[6:7], s27, v104
    v_add_f32 v5, abs(v96), abs(v97)
    v_add_f32 v6, abs(v98), abs(v99)
    v_add_f32 v105, abs(v100), abs(v101)
    v_add_f32 v106, abs(v102), abs(v103)
    v_add_f32 v5, v5, v6
    v_add_f32 v105, v105, v106
    v_add_f32 v5, v5, v105
    v_cmp_nge_f32 vcc, s28, v5
    s_or_b64 s[30:31], s[30:31], s[6:7]
    s_nop 0
    s_or_b64 s[30:31], s[30:31], vcc
    s_cselect_b32 s5, 1, 0
    s_cmp_gt_u32 s5, s34
    s_cbranch_scc1 ac_slow
    s_setprio 0
    v_bfe_u32 v4, v0, 2, 2
    v_bfe_u32 v5, v0, 4, 1
    v_lshlrev_b32 v5, 5, v5
    v_and_b32 v6, 3, v0
    v_lshl_add_u32 v5, v6, 3, v5
    v_lshl_add_u32 v6, v3, 2, v4
    v_mul_u32_u24 v41, 192, v6
    v_add_u32 v41, v41, v5
    v_add_u32 v42, 65536, v41
    v_add_u32 v43, 131072, v41
    v_lshlrev_b32 v37, 4, v3
    v_add_u32 v37, 159744, v37
    s_cmp_ge_u32 s18, 4
    s_cbranch_scc1 ac_loader
    v_lshl_add_u32 v6, v3, 3, v4
    v_lshl_add_u32 v5, v6, 7, v5
    s_lshl_b32 s5, s23, 13
    v_add_u32 v5, s5, v5
    v_lshrrev_b32 v4, 1, v4
    v_xor_b32 v4, s23, v4
    v_lshl_add_u32 v44, v4, 6, v5
    v_xor_b32 v47, 64, v44
    s_lshl_b32 s5, s18, 12
    s_add_u32 s5, s5, 139264
    v_add_u32 v34, s5, v7
    s_xor_b32 s5, s18, 2
    s_lshl_b32 s5, s5, 12
    s_add_u32 s5, s5, 139264
    v_add_u32 v35, s5, v7
    v_lshlrev_b32 v4, 4, v2
    v_lshl_add_u32 v36, v3, 2, v4
    s_lshl_b32 s27, s24, 12
    s_bfe_u32 s5, s58, 0x20001
    s_lshl_b32 s5, s5, 10
    s_add_u32 s27, s27, s5
    s_lshr_b32 s5, s58, 3
    s_lshl_b32 s5, s5, 9
    s_add_u32 s27, s27, s5
    s_and_b32 s5, s58, 1
    s_lshl_b32 s5, s5, 3
    s_add_u32 s27, s27, s5
    s_add_u32 s27, s27, 0x1000000
    v_lshl_add_u32 v10, v3, 4, v10
    v_lshlrev_b32 v39, 5, v2
    v_lshl_add_u32 v39, v3, 4, v39
    v_and_b32 v40, 15, v0
    v_lshlrev_b32 v40, 7, v40
    s_mov_b32 s42, 0xffff0000
    s_lshl_b32 s59, s17, 2
    s_add_u32 s59, s59, s18
    s_lshl_b32 s59, s59, 2
    s_add_u32 s59, s59, s35
    v_and_b32 v4, 5, v0
    s_lshl_b32 s5, s23, 2
    s_add_u32 s5, s5, s22
    v_cmp_eq_u32 s[28:29], s5, v4
    v_and_b32 v4, 3, v0
    v_cmp_eq_u32 s[30:31], s56, v4
    v_lshrrev_b32 v4, 2, v1
    s_mul_i32 s5, s23, 7
    v_subrev_u32 v4, s5, v4
    v_cmp_gt_u32 vcc, 8, v4
    s_lshl_b32 s26, s24, 15
    s_lshl_b32 s5, s58, 11
    s_add_u32 s26, s26, s5
    s_and_b64 s[30:31], s[30:31], vcc
    s_lshl_b32 s5, s24, 1
    s_add_u32 s5, s5, s23
    s_lshl_b32 s19, s5, 14
    s_add_u32 s19, s19, 0x800000
    s_lshl_b32 s32, s5, 11
    s_add_u32 s32, s32, s43
    s_waitcnt vmcnt(0)
    s_mov_b64 exec, 1
    buffer_store_dword v11, off, s[12:15], s21 sc1
    s_mov_b64 exec, -1
    s_barrier
    s_mov_b32 s5, 0
    v_and_b32 v6, 60, v8
idp_11:
    v_and_b32 v4, -16, v9
    v_cmp_ne_u32 vcc, s100, v4
    s_cbranch_vccz idd_12
    buffer_load_dword v9, v6, s[12:15], s88 offen offset:768 sc1
    s_add_u32 s5, s5, 1
    s_waitcnt vmcnt(0)
    s_cmp_lt_u32 s5, 262144
    s_cbranch_scc1 idp_11
idd_12:
    v_readfirstlane_b32 s5, v9
    s_nop 1
    v_cmp_ne_u32 vcc, s5, v9
    s_nop 0
    s_cmp_eq_u64 vcc, 0
    s_cselect_b32 s34, 1, 0
    ds_read_b64_tr_b16 v[108:109], v44 offset:0
    ds_read_b64_tr_b16 v[110:111], v44 offset:512
    ds_read_b64_tr_b16 v[112:113], v47 offset:0
    ds_read_b64_tr_b16 v[114:115], v47 offset:512
    ds_read_b64_tr_b16 v[116:117], v44 offset:2048
    ds_read_b64_tr_b16 v[118:119], v44 offset:2560
    ds_read_b64_tr_b16 v[120:121], v47 offset:2048
    ds_read_b64_tr_b16 v[122:123], v47 offset:2560
    v_lshlrev_b32 v208, 16, v24
    v_and_b32 v209, s42, v24
    v_lshlrev_b32 v210, 16, v25
    v_and_b32 v211, s42, v25
    v_lshlrev_b32 v212, 16, v26
    v_and_b32 v213, s42, v26
    v_lshlrev_b32 v214, 16, v27
    v_and_b32 v215, s42, v27
    v_lshlrev_b32 v216, 16, v28
    v_and_b32 v217, s42, v28
    v_lshlrev_b32 v218, 16, v29
    v_and_b32 v219, s42, v29
    v_lshlrev_b32 v220, 16, v30
    v_and_b32 v221, s42, v30
    v_lshlrev_b32 v222, 16, v31
    v_and_b32 v223, s42, v31
    s_mov_b32 s5, 0
poll_13:
    buffer_load_dword v32, v40, s[12:15], s32 offen offset:0 sc1
    s_add_u32 s5, s5, 1
    s_cmp_gt_u32 s5, 262144
    s_cbranch_scc1 polld_14
    s_waitcnt vmcnt(0)
    v_cmp_ne_u32 vcc, s100, v32
    s_cbranch_vccnz poll_13
polld_14:
    buffer_load_dwordx4 v[144:147], v7, s[12:15], s19 offen offset:0 sc1
    buffer_load_dwordx4 v[148:151], v7, s[12:15], s19 offen offset:1024 sc1
    buffer_load_dwordx4 v[152:155], v7, s[12:15], s19 offen offset:2048 sc1
    buffer_load_dwordx4 v[156:159], v7, s[12:15], s19 offen offset:3072 sc1
    s_add_u32 s19, s19, 4096
    buffer_load_dwordx4 v[160:163], v7, s[12:15], s19 offen offset:0 sc1
    buffer_load_dwordx4 v[164:167], v7, s[12:15], s19 offen offset:1024 sc1
    buffer_load_dwordx4 v[168:171], v7, s[12:15], s19 offen offset:2048 sc1
    buffer_load_dwordx4 v[172:175], v7, s[12:15], s19 offen offset:3072 sc1
    s_add_u32 s19, s19, 4096
    buffer_load_dwordx4 v[176:179], v7, s[12:15], s19 offen offset:0 sc1
    buffer_load_dwordx4 v[180:183], v7, s[12:15], s19 offen offset:1024 sc1
    s_waitcnt vmcnt(9) lgkmcnt(4)
    v_mfma_f32_32x32x16_bf16 v[76:91], v[112:115], v[144:147], 0
    ds_read_b64_tr_b16 v[128:129], v47 offset:4096
    ds_read_b64_tr_b16 v[130:131], v47 offset:4608
    buffer_load_dwordx4 v[184:187], v7, s[12:15], s19 offen offset:2048 sc1
    v_mfma_f32_32x32x16_bf16 v[60:75], v[108:111], v[144:147], 0
    ds_read_b64_tr_b16 v[124:125], v44 offset:4096
    ds_read_b64_tr_b16 v[126:127], v44 offset:4608
    s_waitcnt vmcnt(9) lgkmcnt(4)
    v_mfma_f32_32x32x16_bf16 v[76:91], v[120:123], v[148:151], v[76:91]
    ds_read_b64_tr_b16 v[112:113], v47 offset:6144
    ds_read_b64_tr_b16 v[114:115], v47 offset:6656
    buffer_load_dwordx4 v[188:191], v7, s[12:15], s19 offen offset:3072 sc1
    s_add_u32 s19, s19, 4096
    v_mfma_f32_32x32x16_bf16 v[60:75], v[116:119], v[148:151], v[60:75]
    ds_read_b64_tr_b16 v[108:109], v44 offset:6144
    ds_read_b64_tr_b16 v[110:111], v44 offset:6656
    s_waitcnt vmcnt(9) lgkmcnt(4)
    v_mfma_f32_32x32x16_bf16 v[76:91], v[128:131], v[152:155], v[76:91]
    ds_read_b64_tr_b16 v[120:121], v47 offset:16384
    ds_read_b64_tr_b16 v[122:123], v47 offset:16896
    buffer_load_dwordx4 v[192:195], v7, s[12:15], s19 offen offset:0 sc1
    v_mfma_f32_32x32x16_bf16 v[60:75], v[124:127], v[152:155], v[60:75]
    ds_read_b64_tr_b16 v[116:117], v44 offset:16384
    ds_read_b64_tr_b16 v[118:119], v44 offset:16896
    s_waitcnt vmcnt(9) lgkmcnt(4)
    v_mfma_f32_32x32x16_bf16 v[76:91], v[112:115], v[156:159], v[76:91]
    ds_read_b64_tr_b16 v[128:129], v47 offset:18432
    ds_read_b64_tr_b16 v[130:131], v47 offset:18944
    buffer_load_dwordx4 v[196:199], v7, s[12:15], s19 offen offset:1024 sc1
    v_mfma_f32_32x32x16_bf16 v[60:75], v[108:111], v[156:159], v[60:75]
    ds_read_b64_tr_b16 v[124:125], v44 offset:18432
    ds_read_b64_tr_b16 v[126:127], v44 offset:18944
    s_waitcnt vmcnt(9) lgkmcnt(4)
    v_mfma_f32_32x32x16_bf16 v[76:91], v[120:123], v[160:163], v[76:91]
    ds_read_b64_tr_b16 v[112:113], v47 offset:20480
    ds_read_b64_tr_b16 v[114:115], v47 offset:20992
    buffer_load_dwordx4 v[200:203], v7, s[12:15], s19 offen offset:2048 sc1
    v_mfma_f32_32x32x16_bf16 v[60:75], v[116:119], v[160:163], v[60:75]
    ds_read_b64_tr_b16 v[108:109], v44 offset:20480
    ds_read_b64_tr_b16 v[110:111], v44 offset:20992
    s_waitcnt vmcnt(9) lgkmcnt(4)
    v_mfma_f32_32x32x16_bf16 v[76:91], v[128:131], v[164:167], v[76:91]
    ds_read_b64_tr_b16 v[120:121], v47 offset:22528
    ds_read_b64_tr_b16 v[122:123], v47 offset:23040
    buffer_load_dwordx4 v[204:207], v7, s[12:15], s19 offen offset:3072 sc1
    s_add_u32 s19, s19, 4096
    v_mfma_f32_32x32x16_bf16 v[60:75], v[124:127], v[164:167], v[60:75]
    ds_read_b64_tr_b16 v[116:117], v44 offset:22528
    ds_read_b64_tr_b16 v[118:119], v44 offset:23040
    s_waitcnt vmcnt(9) lgkmcnt(4)
    v_mfma_f32_32x32x16_bf16 v[76:91], v[112:115], v[168:171], v[76:91]
    ds_read_b64_tr_b16 v[128:129], v47 offset:32768
    ds_read_b64_tr_b16 v[130:131], v47 offset:33280
    v_mfma_f32_32x32x16_bf16 v[60:75], v[108:111], v[168:171], v[60:75]
    ds_read_b64_tr_b16 v[124:125], v44 offset:32768
    ds_read_b64_tr_b16 v[126:127], v44 offset:33280
    s_waitcnt vmcnt(8) lgkmcnt(4)
    v_mfma_f32_32x32x16_bf16 v[76:91], v[120:123], v[172:175], v[76:91]
    ds_read_b64_tr_b16 v[112:113], v47 offset:34816
    ds_read_b64_tr_b16 v[114:115], v47 offset:35328
    v_mfma_f32_32x32x16_bf16 v[60:75], v[116:119], v[172:175], v[60:75]
    ds_read_b64_tr_b16 v[108:109], v44 offset:34816
    ds_read_b64_tr_b16 v[110:111], v44 offset:35328
    s_waitcnt vmcnt(7) lgkmcnt(4)
    v_mfma_f32_32x32x16_bf16 v[76:91], v[128:131], v[176:179], v[76:91]
    ds_read_b64_tr_b16 v[120:121], v47 offset:36864
    ds_read_b64_tr_b16 v[122:123], v47 offset:37376
    v_mfma_f32_32x32x16_bf16 v[60:75], v[124:127], v[176:179], v[60:75]
    ds_read_b64_tr_b16 v[116:117], v44 offset:36864
    ds_read_b64_tr_b16 v[118:119], v44 offset:37376
    s_waitcnt vmcnt(6) lgkmcnt(4)
    v_mfma_f32_32x32x16_bf16 v[76:91], v[112:115], v[180:183], v[76:91]
    ds_read_b64_tr_b16 v[128:129], v47 offset:38912
    ds_read_b64_tr_b16 v[130:131], v47 offset:39424
    v_mfma_f32_32x32x16_bf16 v[60:75], v[108:111], v[180:183], v[60:75]
    ds_read_b64_tr_b16 v[124:125], v44 offset:38912
    ds_read_b64_tr_b16 v[126:127], v44 offset:39424
    s_waitcnt vmcnt(5) lgkmcnt(4)
    v_mfma_f32_32x32x16_bf16 v[76:91], v[120:123], v[184:187], v[76:91]
    ds_read_b64_tr_b16 v[112:113], v47 offset:49152
    ds_read_b64_tr_b16 v[114:115], v47 offset:49664
    v_mfma_f32_32x32x16_bf16 v[60:75], v[116:119], v[184:187], v[60:75]
    ds_read_b64_tr_b16 v[108:109], v44 offset:49152
    ds_read_b64_tr_b16 v[110:111], v44 offset:49664
    s_waitcnt vmcnt(4) lgkmcnt(4)
    v_mfma_f32_32x32x16_bf16 v[76:91], v[128:131], v[188:191], v[76:91]
    ds_read_b64_tr_b16 v[120:121], v47 offset:51200
    ds_read_b64_tr_b16 v[122:123], v47 offset:51712
    v_mfma_f32_32x32x16_bf16 v[60:75], v[124:127], v[188:191], v[60:75]
    ds_read_b64_tr_b16 v[116:117], v44 offset:51200
    ds_read_b64_tr_b16 v[118:119], v44 offset:51712
    s_waitcnt vmcnt(3) lgkmcnt(4)
    v_mfma_f32_32x32x16_bf16 v[76:91], v[112:115], v[192:195], v[76:91]
    ds_read_b64_tr_b16 v[128:129], v47 offset:53248
    ds_read_b64_tr_b16 v[130:131], v47 offset:53760
    v_mfma_f32_32x32x16_bf16 v[60:75], v[108:111], v[192:195], v[60:75]
    ds_read_b64_tr_b16 v[124:125], v44 offset:53248
    ds_read_b64_tr_b16 v[126:127], v44 offset:53760
    s_waitcnt vmcnt(2) lgkmcnt(4)
    v_mfma_f32_32x32x16_bf16 v[76:91], v[120:123], v[196:199], v[76:91]
    ds_read_b64_tr_b16 v[112:113], v47 offset:55296
    ds_read_b64_tr_b16 v[114:115], v47 offset:55808
    v_mfma_f32_32x32x16_bf16 v[60:75], v[116:119], v[196:199], v[60:75]
    ds_read_b64_tr_b16 v[108:109], v44 offset:55296
    ds_read_b64_tr_b16 v[110:111], v44 offset:55808
    s_waitcnt vmcnt(1) lgkmcnt(4)
    v_mfma_f32_32x32x16_bf16 v[76:91], v[128:131], v[200:203], v[76:91]
    v_mfma_f32_32x32x16_bf16 v[60:75], v[124:127], v[200:203], v[60:75]
    s_waitcnt vmcnt(0) lgkmcnt(0)
    v_mfma_f32_32x32x16_bf16 v[76:91], v[112:115], v[204:207], v[76:91]
    v_mfma_f32_32x32x16_bf16 v[60:75], v[108:111], v[204:207], v[60:75]
    s_mov_b32 s40, 1.0
    s_mov_b32 s41, s40
    s_nop 8
    ds_write_b128 v34, v[76:79] offset:0
    ds_write_b128 v34, v[80:83] offset:1024
    ds_write_b128 v34, v[84:87] offset:2048
    ds_write_b128 v34, v[88:91] offset:3072
    v_pk_fma_f32 v[60:61], v[60:61], s[40:41], v[208:209]
    v_pk_fma_f32 v[62:63], v[62:63], s[40:41], v[210:211]
    v_pk_fma_f32 v[64:65], v[64:65], s[40:41], v[212:213]
    v_pk_fma_f32 v[66:67], v[66:67], s[40:41], v[214:215]
    v_pk_fma_f32 v[68:69], v[68:69], s[40:41], v[216:217]
    v_pk_fma_f32 v[70:71], v[70:71], s[40:41], v[218:219]
    v_pk_fma_f32 v[72:73], v[72:73], s[40:41], v[220:221]
    v_pk_fma_f32 v[74:75], v[74:75], s[40:41], v[222:223]
    s_waitcnt lgkmcnt(0)
    s_barrier
    ds_read_b128 v[76:79], v35 offset:0
    ds_read_b128 v[80:83], v35 offset:1024
    ds_read_b128 v[84:87], v35 offset:2048
    ds_read_b128 v[88:91], v35 offset:3072
    s_waitcnt lgkmcnt(3)
    v_pk_fma_f32 v[60:61], v[76:77], s[40:41], v[60:61]
    v_pk_fma_f32 v[62:63], v[78:79], s[40:41], v[62:63]
    s_waitcnt lgkmcnt(2)
    v_pk_fma_f32 v[64:65], v[80:81], s[40:41], v[64:65]
    v_pk_fma_f32 v[66:67], v[82:83], s[40:41], v[66:67]
    s_waitcnt lgkmcnt(1)
    v_pk_fma_f32 v[68:69], v[84:85], s[40:41], v[68:69]
    v_pk_fma_f32 v[70:71], v[86:87], s[40:41], v[70:71]
    s_waitcnt lgkmcnt(0)
    v_pk_fma_f32 v[72:73], v[88:89], s[40:41], v[72:73]
    v_pk_fma_f32 v[74:75], v[90:91], s[40:41], v[74:75]
    v_cvt_pk_bf16_f32 v24, v60, v61
    v_cvt_pk_bf16_f32 v25, v62, v63
    v_cvt_pk_bf16_f32 v26, v64, v65
    v_cvt_pk_bf16_f32 v27, v66, v67
    v_cvt_pk_bf16_f32 v28, v68, v69
    v_cvt_pk_bf16_f32 v29, v70, v71
    v_cvt_pk_bf16_f32 v30, v72, v73
    v_cvt_pk_bf16_f32 v31, v74, v75
    s_cmp_eq_u32 s34, 1
    s_cbranch_scc0 st_15
    buffer_store_dwordx4 v[24:27], v7, s[12:15], s26 offen nt
    buffer_store_dwordx4 v[28:31], v7, s[12:15], s26 offen offset:1024 nt
st_16:
    v_pk_add_f32 v[56:57], v[60:61], v[62:63]
    v_pk_mul_f32 v[58:59], v[60:61], v[60:61]
    v_pk_add_f32 v[76:77], v[64:65], v[66:67]
    v_pk_mul_f32 v[78:79], v[62:63], v[62:63]
    v_pk_fma_f32 v[58:59], v[64:65], v[64:65], v[58:59]
    v_pk_fma_f32 v[78:79], v[66:67], v[66:67], v[78:79]
    v_pk_add_f32 v[56:57], v[56:57], v[68:69]
    v_pk_fma_f32 v[58:59], v[68:69], v[68:69], v[58:59]
    v_pk_add_f32 v[76:77], v[76:77], v[70:71]
    v_pk_fma_f32 v[78:79], v[70:71], v[70:71], v[78:79]
    v_pk_add_f32 v[56:57], v[56:57], v[72:73]
    v_pk_fma_f32 v[58:59], v[72:73], v[72:73], v[58:59]
    v_pk_add_f32 v[76:77], v[76:77], v[74:75]
    v_pk_fma_f32 v[78:79], v[74:75], v[74:75], v[78:79]
    v_pk_add_f32 v[56:57], v[56:57], v[76:77]
    v_pk_add_f32 v[58:59], v[58:59], v[78:79]
    v_add_f32 v56, v56, v57
    v_add_f32 v58, v58, v59
    s_nop 1
    v_permlane32_swap_b32 v56, v58
    s_nop 1
    v_add_f32 v56, v56, v58
    s_cmp_eq_u32 s34, 1
    s_cbranch_scc0 st_17
    buffer_store_dword v56, v36, s[12:15], s27 offen
st_18:
    v_lshlrev_b32 v4, 9, v3
    v_sub_u32 v44, v44, v4
    v_add_u32 v45, 65536, v44
    v_add_u32 v46, 131072, v44
    v_sub_u32 v47, v47, v4
    v_add_u32 v48, 65536, v47
    v_add_u32 v49, 131072, v47
    v_subrev_u32 v34, 139264, v34
    v_subrev_u32 v35, 139264, v35
    s_waitcnt vmcnt(0)
    s_mov_b64 exec, 1
    s_cmp_eq_u32 s34, 1
    s_cbranch_scc0 st_19
    buffer_store_dword v11, off, s[12:15], s59 offset:0
st_20:
    s_mov_b64 exec, -1
    s_barrier
    ds_read_b64_tr_b16 v[108:109], v42 offset:0
    ds_read_b64_tr_b16 v[110:111], v42 offset:1536
    ds_read_b64_tr_b16 v[112:113], v42 offset:64
    ds_read_b64_tr_b16 v[114:115], v42 offset:1600
    ds_read_b64_tr_b16 v[116:117], v42 offset:128
    ds_read_b64_tr_b16 v[118:119], v42 offset:1664
    ds_read_b64_tr_b16 v[120:121], v42 offset:3072
    ds_read_b64_tr_b16 v[122:123], v42 offset:4608
    ds_read_b64_tr_b16 v[124:125], v42 offset:3136
    ds_read_b64_tr_b16 v[126:127], v42 offset:4672
    ds_read_b64_tr_b16 v[128:129], v42 offset:3200
    ds_read_b64_tr_b16 v[130:131], v42 offset:4736
    s_lshl_b32 s19, s57, 15
    s_lshl_b32 s20, s57, 12
    s_add_u32 s20, s20, 0x1000000
    s_mov_b32 s5, 0
poll_21:
    buffer_load_dword v32, v8, s[12:15], s35 offen offset:0 sc1
    s_add_u32 s5, s5, 1
    s_cmp_gt_u32 s5, 262144
    s_cbranch_scc1 polld_22
    s_waitcnt vmcnt(0)
    v_cmp_ne_u32 vcc, s100, v32
    s_and_b64 vcc, vcc, s[28:29]
    s_cbranch_scc1 poll_21
polld_22:
    s_cmp_eq_u32 s17, 15
    s_cbranch_scc1 ac_f1idle
    buffer_load_dwordx4 v[144:147], v7, s[12:15], s19 offen offset:0 sc1
    buffer_load_dwordx4 v[148:151], v7, s[12:15], s19 offen offset:1024 sc1
    buffer_load_dwordx4 v[152:155], v7, s[12:15], s19 offen offset:2048 sc1
    buffer_load_dwordx4 v[156:159], v7, s[12:15], s19 offen offset:3072 sc1
    s_add_u32 s19, s19, 4096
    buffer_load_dwordx4 v[160:163], v7, s[12:15], s19 offen offset:0 sc1
    s_waitcnt vmcnt(4) lgkmcnt(6)
    v_mfma_f32_32x32x16_bf16 v[60:75], v[108:111], v[144:147], 0
    ds_read_b64_tr_b16 v[132:133], v42 offset:6144
    ds_read_b64_tr_b16 v[134:135], v42 offset:7680
    buffer_load_dwordx4 v[164:167], v7, s[12:15], s19 offen offset:1024 sc1
    v_mfma_f32_32x32x16_bf16 v[76:91], v[112:115], v[144:147], 0
    ds_read_b64_tr_b16 v[136:137], v42 offset:6208
    ds_read_b64_tr_b16 v[138:139], v42 offset:7744
    buffer_load_dwordx4 v[168:171], v7, s[12:15], s19 offen offset:2048 sc1
    v_mfma_f32_32x32x16_bf16 v[92:107], v[116:119], v[144:147], 0
    ds_read_b64_tr_b16 v[140:141], v42 offset:6272
    ds_read_b64_tr_b16 v[142:143], v42 offset:7808
    s_waitcnt vmcnt(5) lgkmcnt(6)
    v_mfma_f32_32x32x16_bf16 v[60:75], v[120:123], v[148:151], v[60:75]
    ds_read_b64_tr_b16 v[108:109], v42 offset:9216
    ds_read_b64_tr_b16 v[110:111], v42 offset:10752
    buffer_load_dwordx4 v[172:175], v7, s[12:15], s19 offen offset:3072 sc1
    s_add_u32 s19, s19, 4096
    v_mfma_f32_32x32x16_bf16 v[76:91], v[124:127], v[148:151], v[76:91]
    ds_read_b64_tr_b16 v[112:113], v42 offset:9280
    ds_read_b64_tr_b16 v[114:115], v42 offset:10816
    v_mfma_f32_32x32x16_bf16 v[92:107], v[128:131], v[148:151], v[92:107]
    ds_read_b64_tr_b16 v[116:117], v42 offset:9344
    ds_read_b64_tr_b16 v[118:119], v42 offset:10880
    s_waitcnt vmcnt(5) lgkmcnt(6)
    v_mfma_f32_32x32x16_bf16 v[60:75], v[132:135], v[152:155], v[60:75]
    ds_read_b64_tr_b16 v[120:121], v42 offset:12288
    ds_read_b64_tr_b16 v[122:123], v42 offset:13824
    buffer_load_dwordx4 v[176:179], v7, s[12:15], s19 offen offset:0 sc1
    v_mfma_f32_32x32x16_bf16 v[76:91], v[136:139], v[152:155], v[76:91]
    ds_read_b64_tr_b16 v[124:125], v42 offset:12352
    ds_read_b64_tr_b16 v[126:127], v42 offset:13888
    buffer_load_dwordx4 v[208:211], v7, s[12:15], s20 offen offset:0 sc1
    v_mfma_f32_32x32x16_bf16 v[92:107], v[140:143], v[152:155], v[92:107]
    ds_read_b64_tr_b16 v[128:129], v42 offset:12416
    ds_read_b64_tr_b16 v[130:131], v42 offset:13952
    s_waitcnt vmcnt(6) lgkmcnt(6)
    v_mfma_f32_32x32x16_bf16 v[60:75], v[108:111], v[156:159], v[60:75]
    ds_read_b64_tr_b16 v[132:133], v42 offset:15360
    ds_read_b64_tr_b16 v[134:135], v42 offset:16896
    buffer_load_dwordx4 v[180:183], v7, s[12:15], s19 offen offset:1024 sc1
    v_mfma_f32_32x32x16_bf16 v[76:91], v[112:115], v[156:159], v[76:91]
    ds_read_b64_tr_b16 v[136:137], v42 offset:15424
    ds_read_b64_tr_b16 v[138:139], v42 offset:16960
    buffer_load_dwordx4 v[212:215], v7, s[12:15], s20 offen offset:1024 sc1
    v_mfma_f32_32x32x16_bf16 v[92:107], v[116:119], v[156:159], v[92:107]
    ds_read_b64_tr_b16 v[140:141], v42 offset:15488
    ds_read_b64_tr_b16 v[142:143], v42 offset:17024
    s_waitcnt vmcnt(7) lgkmcnt(6)
    v_mfma_f32_32x32x16_bf16 v[60:75], v[120:123], v[160:163], v[60:75]
    ds_read_b64_tr_b16 v[108:109], v42 offset:18432
    ds_read_b64_tr_b16 v[110:111], v42 offset:19968
    buffer_load_dwordx4 v[184:187], v7, s[12:15], s19 offen offset:2048 sc1
    v_mfma_f32_32x32x16_bf16 v[76:91], v[124:127], v[160:163], v[76:91]
    ds_read_b64_tr_b16 v[112:113], v42 offset:18496
    ds_read_b64_tr_b16 v[114:115], v42 offset:20032
    buffer_load_dwordx4 v[216:219], v7, s[12:15], s20 offen offset:2048 sc1
    v_mfma_f32_32x32x16_bf16 v[92:107], v[128:131], v[160:163], v[92:107]
    ds_read_b64_tr_b16 v[116:117], v42 offset:18560
    ds_read_b64_tr_b16 v[118:119], v42 offset:20096
    s_waitcnt vmcnt(8) lgkmcnt(6)
    v_mfma_f32_32x32x16_bf16 v[60:75], v[132:135], v[164:167], v[60:75]
    ds_read_b64_tr_b16 v[120:121], v42 offset:21504
    ds_read_b64_tr_b16 v[122:123], v42 offset:23040
    buffer_load_dwordx4 v[188:191], v7, s[12:15], s19 offen offset:3072 sc1
    s_add_u32 s19, s19, 4096
    v_mfma_f32_32x32x16_bf16 v[76:91], v[136:139], v[164:167], v[76:91]
    ds_read_b64_tr_b16 v[124:125], v42 offset:21568
    ds_read_b64_tr_b16 v[126:127], v42 offset:23104
    buffer_load_dwordx4 v[220:223], v7, s[12:15], s20 offen offset:3072 sc1
    v_mfma_f32_32x32x16_bf16 v[92:107], v[140:143], v[164:167], v[92:107]
    ds_read_b64_tr_b16 v[128:129], v42 offset:21632
    ds_read_b64_tr_b16 v[130:131], v42 offset:23168
    s_waitcnt vmcnt(9) lgkmcnt(6)
    v_mfma_f32_32x32x16_bf16 v[60:75], v[108:111], v[168:171], v[60:75]
    ds_read_b64_tr_b16 v[132:133], v42 offset:24576
    ds_read_b64_tr_b16 v[134:135], v42 offset:26112
    buffer_load_dwordx4 v[192:195], v7, s[12:15], s19 offen offset:0 sc1
    v_mfma_f32_32x32x16_bf16 v[76:91], v[112:115], v[168:171], v[76:91]
    ds_read_b64_tr_b16 v[136:137], v42 offset:24640
    ds_read_b64_tr_b16 v[138:139], v42 offset:26176
    buffer_load_dwordx4 v[196:199], v7, s[12:15], s19 offen offset:1024 sc1
    v_mfma_f32_32x32x16_bf16 v[92:107], v[116:119], v[168:171], v[92:107]
    ds_read_b64_tr_b16 v[140:141], v42 offset:24704
    ds_read_b64_tr_b16 v[142:143], v42 offset:26240
    s_waitcnt vmcnt(10) lgkmcnt(6)
    v_mfma_f32_32x32x16_bf16 v[60:75], v[120:123], v[172:175], v[60:75]
    ds_read_b64_tr_b16 v[108:109], v42 offset:27648
    ds_read_b64_tr_b16 v[110:111], v42 offset:29184
    buffer_load_dwordx4 v[200:203], v7, s[12:15], s19 offen offset:2048 sc1
    v_mfma_f32_32x32x16_bf16 v[76:91], v[124:127], v[172:175], v[76:91]
    ds_read_b64_tr_b16 v[112:113], v42 offset:27712
    ds_read_b64_tr_b16 v[114:115], v42 offset:29248
    v_mfma_f32_32x32x16_bf16 v[92:107], v[128:131], v[172:175], v[92:107]
    ds_read_b64_tr_b16 v[116:117], v42 offset:27776
    ds_read_b64_tr_b16 v[118:119], v42 offset:29312
    s_waitcnt vmcnt(10) lgkmcnt(6)
    v_mfma_f32_32x32x16_bf16 v[60:75], v[132:135], v[176:179], v[60:75]
    ds_read_b64_tr_b16 v[120:121], v42 offset:30720
    ds_read_b64_tr_b16 v[122:123], v42 offset:32256
    buffer_load_dwordx4 v[204:207], v7, s[12:15], s19 offen offset:3072 sc1
    s_add_u32 s19, s19, 4096
    v_mfma_f32_32x32x16_bf16 v[76:91], v[136:139], v[176:179], v[76:91]
    ds_read_b64_tr_b16 v[124:125], v42 offset:30784
    ds_read_b64_tr_b16 v[126:127], v42 offset:32320
    v_mfma_f32_32x32x16_bf16 v[92:107], v[140:143], v[176:179], v[92:107]
    ds_read_b64_tr_b16 v[128:129], v42 offset:30848
    ds_read_b64_tr_b16 v[130:131], v42 offset:32384
    s_waitcnt vmcnt(9) lgkmcnt(6)
    v_mfma_f32_32x32x16_bf16 v[60:75], v[108:111], v[180:183], v[60:75]
    ds_read_b64_tr_b16 v[132:133], v42 offset:33792
    ds_read_b64_tr_b16 v[134:135], v42 offset:35328
    buffer_load_dwordx4 v[144:147], v7, s[12:15], s19 offen offset:0 sc1
    v_mfma_f32_32x32x16_bf16 v[76:91], v[112:115], v[180:183], v[76:91]
    ds_read_b64_tr_b16 v[136:137], v42 offset:33856
    ds_read_b64_tr_b16 v[138:139], v42 offset:35392
    v_mfma_f32_32x32x16_bf16 v[92:107], v[116:119], v[180:183], v[92:107]
    ds_read_b64_tr_b16 v[140:141], v42 offset:33920
    ds_read_b64_tr_b16 v[142:143], v42 offset:35456
    s_waitcnt vmcnt(8) lgkmcnt(6)
    v_mfma_f32_32x32x16_bf16 v[60:75], v[120:123], v[184:187], v[60:75]
    ds_read_b64_tr_b16 v[108:109], v42 offset:36864
    ds_read_b64_tr_b16 v[110:111], v42 offset:38400
    buffer_load_dwordx4 v[148:151], v7, s[12:15], s19 offen offset:1024 sc1
    v_mfma_f32_32x32x16_bf16 v[76:91], v[124:127], v[184:187], v[76:91]
    ds_read_b64_tr_b16 v[112:113], v42 offset:36928
    ds_read_b64_tr_b16 v[114:115], v42 offset:38464
    v_mfma_f32_32x32x16_bf16 v[92:107], v[128:131], v[184:187], v[92:107]
    ds_read_b64_tr_b16 v[116:117], v42 offset:36992
    ds_read_b64_tr_b16 v[118:119], v42 offset:38528
    s_waitcnt vmcnt(7) lgkmcnt(6)
    v_mfma_f32_32x32x16_bf16 v[60:75], v[132:135], v[188:191], v[60:75]
    ds_read_b64_tr_b16 v[120:121], v42 offset:39936
    ds_read_b64_tr_b16 v[122:123], v42 offset:41472
    buffer_load_dwordx4 v[152:155], v7, s[12:15], s19 offen offset:2048 sc1
    v_mfma_f32_32x32x16_bf16 v[76:91], v[136:139], v[188:191], v[76:91]
    ds_read_b64_tr_b16 v[124:125], v42 offset:40000
    ds_read_b64_tr_b16 v[126:127], v42 offset:41536
    v_mfma_f32_32x32x16_bf16 v[92:107], v[140:143], v[188:191], v[92:107]
    ds_read_b64_tr_b16 v[128:129], v42 offset:40064
    ds_read_b64_tr_b16 v[130:131], v42 offset:41600
    s_waitcnt vmcnt(6) lgkmcnt(6)
    v_mfma_f32_32x32x16_bf16 v[60:75], v[108:111], v[192:195], v[60:75]
    ds_read_b64_tr_b16 v[132:133], v42 offset:43008
    ds_read_b64_tr_b16 v[134:135], v42 offset:44544
    buffer_load_dwordx4 v[156:159], v7, s[12:15], s19 offen offset:3072 sc1
    s_add_u32 s19, s19, 4096
    v_mfma_f32_32x32x16_bf16 v[76:91], v[112:115], v[192:195], v[76:91]
    ds_read_b64_tr_b16 v[136:137], v42 offset:43072
    ds_read_b64_tr_b16 v[138:139], v42 offset:44608
    v_mfma_f32_32x32x16_bf16 v[92:107], v[116:119], v[192:195], v[92:107]
    ds_read_b64_tr_b16 v[140:141], v42 offset:43136
    ds_read_b64_tr_b16 v[142:143], v42 offset:44672
    s_waitcnt vmcnt(6) lgkmcnt(6)
    v_mfma_f32_32x32x16_bf16 v[60:75], v[120:123], v[196:199], v[60:75]
    ds_read_b64_tr_b16 v[108:109], v42 offset:46080
    ds_read_b64_tr_b16 v[110:111], v42 offset:47616
    buffer_load_dwordx4 v[160:163], v7, s[12:15], s19 offen offset:0 sc1
    v_mfma_f32_32x32x16_bf16 v[76:91], v[124:127], v[196:199], v[76:91]
    ds_read_b64_tr_b16 v[112:113], v42 offset:46144
    ds_read_b64_tr_b16 v[114:115], v42 offset:47680
    v_mfma_f32_32x32x16_bf16 v[92:107], v[128:131], v[196:199], v[92:107]
    ds_read_b64_tr_b16 v[116:117], v42 offset:46208
    ds_read_b64_tr_b16 v[118:119], v42 offset:47744
    s_waitcnt vmcnt(6) lgkmcnt(6)
    v_mfma_f32_32x32x16_bf16 v[60:75], v[132:135], v[200:203], v[60:75]
    ds_read_b64_tr_b16 v[120:121], v42 offset:49152
    ds_read_b64_tr_b16 v[122:123], v42 offset:50688
    buffer_load_dwordx4 v[164:167], v7, s[12:15], s19 offen offset:1024 sc1
    v_add_f32 v208, v208, v216
    v_add_f32 v209, v209, v217
    v_mfma_f32_32x32x16_bf16 v[76:91], v[136:139], v[200:203], v[76:91]
    ds_read_b64_tr_b16 v[124:125], v42 offset:49216
    ds_read_b64_tr_b16 v[126:127], v42 offset:50752
    v_add_f32 v210, v210, v218
    v_add_f32 v211, v211, v219
    v_mfma_f32_32x32x16_bf16 v[92:107], v[140:143], v[200:203], v[92:107]
    ds_read_b64_tr_b16 v[128:129], v42 offset:49280
    ds_read_b64_tr_b16 v[130:131], v42 offset:50816
    v_add_f32 v212, v212, v220
    v_add_f32 v213, v213, v221
    s_waitcnt vmcnt(6) lgkmcnt(6)
    v_mfma_f32_32x32x16_bf16 v[60:75], v[108:111], v[204:207], v[60:75]
    ds_read_b64_tr_b16 v[132:133], v42 offset:52224
    ds_read_b64_tr_b16 v[134:135], v42 offset:53760
    buffer_load_dwordx4 v[168:171], v7, s[12:15], s19 offen offset:2048 sc1
    v_add_f32 v214, v214, v222
    v_add_f32 v215, v215, v223
    v_mfma_f32_32x32x16_bf16 v[76:91], v[112:115], v[204:207], v[76:91]
    ds_read_b64_tr_b16 v[136:137], v42 offset:52288
    ds_read_b64_tr_b16 v[138:139], v42 offset:53824
    v_add_f32 v208, v208, v212
    v_add_f32 v209, v209, v213
    v_mfma_f32_32x32x16_bf16 v[92:107], v[116:119], v[204:207], v[92:107]
    ds_read_b64_tr_b16 v[140:141], v42 offset:52352
    ds_read_b64_tr_b16 v[142:143], v42 offset:53888
    v_add_f32 v210, v210, v214
    v_add_f32 v211, v211, v215
    s_waitcnt vmcnt(6) lgkmcnt(6)
    v_mfma_f32_32x32x16_bf16 v[60:75], v[120:123], v[144:147], v[60:75]
    ds_read_b64_tr_b16 v[108:109], v42 offset:55296
    ds_read_b64_tr_b16 v[110:111], v42 offset:56832
    buffer_load_dwordx4 v[172:175], v7, s[12:15], s19 offen offset:3072 sc1
    s_add_u32 s19, s19, 4096
    v_add_f32 v208, v208, v210
    v_add_f32 v209, v209, v211
    v_mfma_f32_32x32x16_bf16 v[76:91], v[124:127], v[144:147], v[76:91]
    ds_read_b64_tr_b16 v[112:113], v42 offset:55360
    ds_read_b64_tr_b16 v[114:115], v42 offset:56896
    v_mov_b32 v4, v208
    v_mov_b32 v5, v209
    v_mfma_f32_32x32x16_bf16 v[92:107], v[128:131], v[144:147], v[92:107]
    ds_read_b64_tr_b16 v[116:117], v42 offset:55424
    ds_read_b64_tr_b16 v[118:119], v42 offset:56960
    s_nop 1
    v_permlane32_swap_b32 v4, v208
    s_waitcnt vmcnt(6) lgkmcnt(6)
    v_mfma_f32_32x32x16_bf16 v[60:75], v[132:135], v[148:151], v[60:75]
    ds_read_b64_tr_b16 v[120:121], v42 offset:58368
    ds_read_b64_tr_b16 v[122:123], v42 offset:59904
    buffer_load_dwordx4 v[176:179], v7, s[12:15], s19 offen offset:0 sc1
    v_permlane32_swap_b32 v5, v209
    s_nop 1
    v_mfma_f32_32x32x16_bf16 v[76:91], v[136:139], v[148:151], v[76:91]
    ds_read_b64_tr_b16 v[124:125], v42 offset:58432
    ds_read_b64_tr_b16 v[126:127], v42 offset:59968
    v_add_f32 v4, v4, v208
    v_add_f32 v5, v5, v209
    v_mfma_f32_32x32x16_bf16 v[92:107], v[140:143], v[148:151], v[92:107]
    ds_read_b64_tr_b16 v[128:129], v42 offset:58496
    ds_read_b64_tr_b16 v[130:131], v42 offset:60032
    v_mul_f32 v50, 0xbb000000, v4
    v_mul_f32 v5, 0x3b000000, v5
    s_waitcnt vmcnt(6) lgkmcnt(6)
    v_mfma_f32_32x32x16_bf16 v[60:75], v[108:111], v[152:155], v[60:75]
    ds_read_b64_tr_b16 v[132:133], v42 offset:61440
    ds_read_b64_tr_b16 v[134:135], v42 offset:62976
    buffer_load_dwordx4 v[180:183], v7, s[12:15], s19 offen offset:1024 sc1
    v_fma_f32 v5, -v50, v50, v5
    v_max_f32 v5, 0, v5
    v_mfma_f32_32x32x16_bf16 v[76:91], v[112:115], v[152:155], v[76:91]
    ds_read_b64_tr_b16 v[136:137], v42 offset:61504
    ds_read_b64_tr_b16 v[138:139], v42 offset:63040
    v_add_f32 v5, 0x3727c5ac, v5
    v_rsq_f32 v52, v5
    v_mfma_f32_32x32x16_bf16 v[92:107], v[116:119], v[152:155], v[92:107]
    ds_read_b64_tr_b16 v[140:141], v42 offset:61568
    ds_read_b64_tr_b16 v[142:143], v42 offset:63104
    s_nop 0
    v_mul_f32 v54, 0x3fb8aa3b, v52
    s_waitcnt vmcnt(6) lgkmcnt(6)
    v_mfma_f32_32x32x16_bf16 v[60:75], v[120:123], v[156:159], v[60:75]
    ds_read_b64_tr_b16 v[108:109], v42 offset:64512
    ds_read_b64_tr_b16 v[110:111], v43 offset:512
    buffer_load_dwordx4 v[184:187], v7, s[12:15], s19 offen offset:2048 sc1
    v_mfma_f32_32x32x16_bf16 v[76:91], v[124:127], v[156:159], v[76:91]
    ds_read_b64_tr_b16 v[112:113], v42 offset:64576
    ds_read_b64_tr_b16 v[114:115], v43 offset:576
    ds_read_b128 v[208:211], v37 offset:512
    ds_read_b128 v[212:215], v37 offset:544
    v_mfma_f32_32x32x16_bf16 v[92:107], v[128:131], v[156:159], v[92:107]
    ds_read_b64_tr_b16 v[116:117], v42 offset:64640
    ds_read_b64_tr_b16 v[118:119], v43 offset:640
    s_waitcnt vmcnt(6) lgkmcnt(8)
    v_mfma_f32_32x32x16_bf16 v[60:75], v[132:135], v[160:163], v[60:75]
    ds_read_b64_tr_b16 v[120:121], v43 offset:2048
    ds_read_b64_tr_b16 v[122:123], v43 offset:3584
    buffer_load_dwordx4 v[188:191], v7, s[12:15], s19 offen offset:3072 sc1
    s_add_u32 s19, s19, 4096
    v_mfma_f32_32x32x16_bf16 v[76:91], v[136:139], v[160:163], v[76:91]
    ds_read_b64_tr_b16 v[124:125], v43 offset:2112
    ds_read_b64_tr_b16 v[126:127], v43 offset:3648
    ds_read_b128 v[216:219], v37 offset:576
    ds_read_b128 v[220:223], v37 offset:608
    v_mfma_f32_32x32x16_bf16 v[92:107], v[140:143], v[160:163], v[92:107]
    ds_read_b64_tr_b16 v[128:129], v43 offset:2176
    ds_read_b64_tr_b16 v[130:131], v43 offset:3712
    s_waitcnt vmcnt(6) lgkmcnt(8)
    v_mfma_f32_32x32x16_bf16 v[60:75], v[108:111], v[164:167], v[60:75]
    ds_read_b64_tr_b16 v[132:133], v43 offset:5120
    ds_read_b64_tr_b16 v[134:135], v43 offset:6656
    buffer_load_dwordx4 v[192:195], v7, s[12:15], s19 offen offset:0 sc1
    v_mfma_f32_32x32x16_bf16 v[76:91], v[112:115], v[164:167], v[76:91]
    ds_read_b64_tr_b16 v[136:137], v43 offset:5184
    ds_read_b64_tr_b16 v[138:139], v43 offset:6720
    ds_read_b128 v[224:227], v37 offset:640
    ds_read_b128 v[228:231], v37 offset:672
    v_mfma_f32_32x32x16_bf16 v[92:107], v[116:119], v[164:167], v[92:107]
    ds_read_b64_tr_b16 v[140:141], v43 offset:5248
    ds_read_b64_tr_b16 v[142:143], v43 offset:6784
    s_waitcnt vmcnt(6) lgkmcnt(8)
    v_mfma_f32_32x32x16_bf16 v[60:75], v[120:123], v[168:171], v[60:75]
    ds_read_b64_tr_b16 v[108:109], v41 offset:0
    ds_read_b64_tr_b16 v[110:111], v41 offset:1536
    buffer_load_dwordx4 v[196:199], v7, s[12:15], s19 offen offset:1024 sc1
    v_mfma_f32_32x32x16_bf16 v[76:91], v[124:127], v[168:171], v[76:91]
    ds_read_b64_tr_b16 v[112:113], v41 offset:64
    ds_read_b64_tr_b16 v[114:115], v41 offset:1600
    ds_read_b128 v[232:235], v37 offset:704
    ds_read_b128 v[236:239], v37 offset:736
    v_mfma_f32_32x32x16_bf16 v[92:107], v[128:131], v[168:171], v[92:107]
    ds_read_b64_tr_b16 v[116:117], v41 offset:128
    ds_read_b64_tr_b16 v[118:119], v41 offset:1664
    s_waitcnt vmcnt(6) lgkmcnt(8)
    v_mfma_f32_32x32x16_bf16 v[60:75], v[132:135], v[172:175], v[60:75]
    ds_read_b64_tr_b16 v[120:121], v41 offset:3072
    ds_read_b64_tr_b16 v[122:123], v41 offset:4608
    buffer_load_dwordx4 v[200:203], v7, s[12:15], s19 offen offset:2048 sc1
    v_mfma_f32_32x32x16_bf16 v[76:91], v[136:139], v[172:175], v[76:91]
    ds_read_b64_tr_b16 v[124:125], v41 offset:3136
    ds_read_b64_tr_b16 v[126:127], v41 offset:4672
    ds_read_b128 v[240:243], v37 offset:768
    ds_read_b128 v[244:247], v37 offset:800
    v_mfma_f32_32x32x16_bf16 v[92:107], v[140:143], v[172:175], v[92:107]
    ds_read_b64_tr_b16 v[128:129], v41 offset:3200
    ds_read_b64_tr_b16 v[130:131], v41 offset:4736
    s_barrier
    s_waitcnt vmcnt(6) lgkmcnt(8)
    v_mfma_f32_32x32x16_bf16 v[60:75], v[108:111], v[176:179], v[60:75]
    ds_read_b64_tr_b16 v[132:133], v41 offset:6144
    ds_read_b64_tr_b16 v[134:135], v41 offset:7680
    buffer_load_dwordx4 v[204:207], v7, s[12:15], s19 offen offset:3072 sc1
    s_add_u32 s19, s19, 4096
    v_mfma_f32_32x32x16_bf16 v[76:91], v[112:115], v[176:179], v[76:91]
    ds_read_b64_tr_b16 v[136:137], v41 offset:6208
    ds_read_b64_tr_b16 v[138:139], v41 offset:7744
    ds_read_b128 v[248:251], v37 offset:832
    ds_read_b128 v[252:255], v37 offset:864
    v_mfma_f32_32x32x16_bf16 v[92:107], v[116:119], v[176:179], v[92:107]
    ds_read_b64_tr_b16 v[140:141], v41 offset:6272
    ds_read_b64_tr_b16 v[142:143], v41 offset:7808
    s_waitcnt vmcnt(6) lgkmcnt(8)
    v_mfma_f32_32x32x16_bf16 v[60:75], v[120:123], v[180:183], v[60:75]
    ds_read_b64_tr_b16 v[108:109], v41 offset:9216
    ds_read_b64_tr_b16 v[110:111], v41 offset:10752
    v_mfma_f32_32x32x16_bf16 v[76:91], v[124:127], v[180:183], v[76:91]
    ds_read_b64_tr_b16 v[112:113], v41 offset:9280
    ds_read_b64_tr_b16 v[114:115], v41 offset:10816
    v_mfma_f32_32x32x16_bf16 v[92:107], v[128:131], v[180:183], v[92:107]
    ds_read_b64_tr_b16 v[116:117], v41 offset:9344
    ds_read_b64_tr_b16 v[118:119], v41 offset:10880
    s_waitcnt vmcnt(5) lgkmcnt(6)
    v_mfma_f32_32x32x16_bf16 v[60:75], v[132:135], v[184:187], v[60:75]
    ds_read_b64_tr_b16 v[120:121], v41 offset:12288
    ds_read_b64_tr_b16 v[122:123], v41 offset:13824
    v_mfma_f32_32x32x16_bf16 v[76:91], v[136:139], v[184:187], v[76:91]
    ds_read_b64_tr_b16 v[124:125], v41 offset:12352
    ds_read_b64_tr_b16 v[126:127], v41 offset:13888
    v_mfma_f32_32x32x16_bf16 v[92:107], v[140:143], v[184:187], v[92:107]
    ds_read_b64_tr_b16 v[128:129], v41 offset:12416
    ds_read_b64_tr_b16 v[130:131], v41 offset:13952
    s_waitcnt vmcnt(4) lgkmcnt(6)
    v_mfma_f32_32x32x16_bf16 v[60:75], v[108:111], v[188:191], v[60:75]
    ds_read_b64_tr_b16 v[132:133], v41 offset:15360
    ds_read_b64_tr_b16 v[134:135], v41 offset:16896
    v_mfma_f32_32x32x16_bf16 v[76:91], v[112:115], v[188:191], v[76:91]
    ds_read_b64_tr_b16 v[136:137], v41 offset:15424
    ds_read_b64_tr_b16 v[138:139], v41 offset:16960
    v_mfma_f32_32x32x16_bf16 v[92:107], v[116:119], v[188:191], v[92:107]
    ds_read_b64_tr_b16 v[140:141], v41 offset:15488
    ds_read_b64_tr_b16 v[142:143], v41 offset:17024
    s_waitcnt vmcnt(3) lgkmcnt(6)
    v_mfma_f32_32x32x16_bf16 v[60:75], v[120:123], v[192:195], v[60:75]
    ds_read_b64_tr_b16 v[108:109], v41 offset:18432
    ds_read_b64_tr_b16 v[110:111], v41 offset:19968
    v_mfma_f32_32x32x16_bf16 v[76:91], v[124:127], v[192:195], v[76:91]
    ds_read_b64_tr_b16 v[112:113], v41 offset:18496
    ds_read_b64_tr_b16 v[114:115], v41 offset:20032
    v_mfma_f32_32x32x16_bf16 v[92:107], v[128:131], v[192:195], v[92:107]
    ds_read_b64_tr_b16 v[116:117], v41 offset:18560
    ds_read_b64_tr_b16 v[118:119], v41 offset:20096
    s_waitcnt vmcnt(2) lgkmcnt(6)
    v_mfma_f32_32x32x16_bf16 v[60:75], v[132:135], v[196:199], v[60:75]
    ds_read_b64_tr_b16 v[120:121], v41 offset:21504
    ds_read_b64_tr_b16 v[122:123], v41 offset:23040
    v_mfma_f32_32x32x16_bf16 v[76:91], v[136:139], v[196:199], v[76:91]
    ds_read_b64_tr_b16 v[124:125], v41 offset:21568
    ds_read_b64_tr_b16 v[126:127], v41 offset:23104
    v_mfma_f32_32x32x16_bf16 v[92:107], v[140:143], v[196:199], v[92:107]
    ds_read_b64_tr_b16 v[128:129], v41 offset:21632
    ds_read_b64_tr_b16 v[130:131], v41 offset:23168
    s_waitcnt vmcnt(1) lgkmcnt(6)
    v_mfma_f32_32x32x16_bf16 v[60:75], v[108:111], v[200:203], v[60:75]
    ds_read_b128 v[144:147], v37 offset:0
    ds_read_b128 v[148:151], v37 offset:32
    v_mfma_f32_32x32x16_bf16 v[76:91], v[112:115], v[200:203], v[76:91]
    ds_read_b128 v[152:155], v37 offset:64
    ds_read_b128 v[156:159], v37 offset:96
    v_mfma_f32_32x32x16_bf16 v[92:107], v[116:119], v[200:203], v[92:107]
    ds_read_b128 v[160:163], v37 offset:128
    ds_read_b128 v[164:167], v37 offset:160
    s_waitcnt vmcnt(0) lgkmcnt(6)
    v_mfma_f32_32x32x16_bf16 v[60:75], v[120:123], v[204:207], v[60:75]
    ds_read_b128 v[168:171], v37 offset:192
    ds_read_b128 v[172:175], v37 offset:224
    v_mfma_f32_32x32x16_bf16 v[76:91], v[124:127], v[204:207], v[76:91]
    ds_read_b128 v[176:179], v37 offset:256
    ds_read_b128 v[180:183], v37 offset:288
    v_mfma_f32_32x32x16_bf16 v[92:107], v[128:131], v[204:207], v[92:107]
    ds_read_b128 v[184:187], v37 offset:320
    ds_read_b128 v[188:191], v37 offset:352
    s_barrier
    s_mov_b32 s40, 1.0
    s_mov_b32 s41, 1.0
    v_mov_b32 v56, 0.5
    s_mul_i32 s21, s57, 88064
    s_mul_i32 s5, s17, 6144
    s_add_u32 s21, s21, s5
    s_add_u32 s21, s21, 0xa00000
    s_add_u32 s20, s21, 4096
    s_waitcnt lgkmcnt(8)
.p2align 3
    v_pk_fma_f32 v[60:61], v[144:145], v[50:51], v[60:61] op_sel_hi:[1,0,1]
    v_pk_fma_f32 v[62:63], v[146:147], v[50:51], v[62:63] op_sel_hi:[1,0,1]
    v_pk_fma_f32 v[64:65], v[148:149], v[50:51], v[64:65] op_sel_hi:[1,0,1]
    v_pk_fma_f32 v[66:67], v[150:151], v[50:51], v[66:67] op_sel_hi:[1,0,1]
    v_pk_fma_f32 v[68:69], v[152:153], v[50:51], v[68:69] op_sel_hi:[1,0,1]
    v_pk_fma_f32 v[70:71], v[154:155], v[50:51], v[70:71] op_sel_hi:[1,0,1]
    v_pk_fma_f32 v[72:73], v[156:157], v[50:51], v[72:73] op_sel_hi:[1,0,1]
    v_pk_fma_f32 v[74:75], v[158:159], v[50:51], v[74:75] op_sel_hi:[1,0,1]
    v_pk_fma_f32 v[60:61], v[60:61], v[54:55], v[208:209] op_sel_hi:[1,0,1]
    v_pk_fma_f32 v[62:63], v[62:63], v[54:55], v[210:211] op_sel_hi:[1,0,1]
    v_pk_fma_f32 v[64:65], v[64:65], v[54:55], v[212:213] op_sel_hi:[1,0,1]
    v_pk_fma_f32 v[66:67], v[66:67], v[54:55], v[214:215] op_sel_hi:[1,0,1]
    v_pk_fma_f32 v[68:69], v[68:69], v[54:55], v[216:217] op_sel_hi:[1,0,1]
    v_pk_fma_f32 v[70:71], v[70:71], v[54:55], v[218:219] op_sel_hi:[1,0,1]
    v_pk_fma_f32 v[72:73], v[72:73], v[54:55], v[220:221] op_sel_hi:[1,0,1]
    v_pk_fma_f32 v[74:75], v[74:75], v[54:55], v[222:223] op_sel_hi:[1,0,1]
    v_exp_f32 v108, v60
    v_exp_f32 v109, v61
    v_exp_f32 v110, v62
    v_exp_f32 v111, v63
    v_exp_f32 v112, v64
    v_exp_f32 v113, v65
    v_exp_f32 v114, v66
    v_exp_f32 v115, v67
    v_exp_f32 v116, v68
    v_exp_f32 v117, v69
    v_exp_f32 v118, v70
    v_exp_f32 v119, v71
    v_exp_f32 v120, v72
    v_exp_f32 v121, v73
    v_exp_f32 v122, v74
    v_exp_f32 v123, v75
    v_pk_fma_f32 v[124:125], v[108:109], v[56:57], s[40:41] op_sel_hi:[1,0,1]
    v_pk_fma_f32 v[126:127], v[110:111], v[56:57], s[40:41] op_sel_hi:[1,0,1]
    v_pk_fma_f32 v[128:129], v[112:113], v[56:57], s[40:41] op_sel_hi:[1,0,1]
    v_pk_fma_f32 v[130:131], v[114:115], v[56:57], s[40:41] op_sel_hi:[1,0,1]
    v_pk_fma_f32 v[132:133], v[116:117], v[56:57], s[40:41] op_sel_hi:[1,0,1]
    v_pk_fma_f32 v[134:135], v[118:119], v[56:57], s[40:41] op_sel_hi:[1,0,1]
    v_pk_fma_f32 v[136:137], v[120:121], v[56:57], s[40:41] op_sel_hi:[1,0,1]
    v_pk_fma_f32 v[138:139], v[122:123], v[56:57], s[40:41] op_sel_hi:[1,0,1]
    v_pk_fma_f32 v[108:109], v[108:109], v[124:125], s[40:41]
    v_pk_fma_f32 v[110:111], v[110:111], v[126:127], s[40:41]
    v_pk_fma_f32 v[112:113], v[112:113], v[128:129], s[40:41]
    v_pk_fma_f32 v[114:115], v[114:115], v[130:131], s[40:41]
    v_pk_fma_f32 v[116:117], v[116:117], v[132:133], s[40:41]
    v_pk_fma_f32 v[118:119], v[118:119], v[134:135], s[40:41]
    v_pk_fma_f32 v[120:121], v[120:121], v[136:137], s[40:41]
    v_pk_fma_f32 v[122:123], v[122:123], v[138:139], s[40:41]
    v_rcp_f32 v108, v108
    v_rcp_f32 v109, v109
    v_rcp_f32 v110, v110
    v_rcp_f32 v111, v111
    v_rcp_f32 v112, v112
    v_rcp_f32 v113, v113
    v_rcp_f32 v114, v114
    v_rcp_f32 v115, v115
    v_rcp_f32 v116, v116
    v_rcp_f32 v117, v117
    v_rcp_f32 v118, v118
    v_rcp_f32 v119, v119
    v_rcp_f32 v120, v120
    v_rcp_f32 v121, v121
    v_rcp_f32 v122, v122
    v_rcp_f32 v123, v123
    v_pk_fma_f32 v[108:109], v[60:61], v[108:109], v[60:61] neg_lo:[1,0,0] neg_hi:[1,0,0]
    v_pk_fma_f32 v[110:111], v[62:63], v[110:111], v[62:63] neg_lo:[1,0,0] neg_hi:[1,0,0]
    v_pk_fma_f32 v[112:113], v[64:65], v[112:113], v[64:65] neg_lo:[1,0,0] neg_hi:[1,0,0]
    v_pk_fma_f32 v[114:115], v[66:67], v[114:115], v[66:67] neg_lo:[1,0,0] neg_hi:[1,0,0]
    v_pk_fma_f32 v[116:117], v[68:69], v[116:117], v[68:69] neg_lo:[1,0,0] neg_hi:[1,0,0]
    v_pk_fma_f32 v[118:119], v[70:71], v[118:119], v[70:71] neg_lo:[1,0,0] neg_hi:[1,0,0]
    v_pk_fma_f32 v[120:121], v[72:73], v[120:121], v[72:73] neg_lo:[1,0,0] neg_hi:[1,0,0]
    v_pk_fma_f32 v[122:123], v[74:75], v[122:123], v[74:75] neg_lo:[1,0,0] neg_hi:[1,0,0]
    v_cvt_pk_bf16_f32 v144, v108, v109
    v_cvt_pk_bf16_f32 v145, v110, v111
    v_cvt_pk_bf16_f32 v146, v112, v113
    v_cvt_pk_bf16_f32 v147, v114, v115
    v_cvt_pk_bf16_f32 v148, v116, v117
    v_cvt_pk_bf16_f32 v149, v118, v119
    v_cvt_pk_bf16_f32 v150, v120, v121
    v_cvt_pk_bf16_f32 v151, v122, v123
    s_cmp_eq_u32 s17, 14
    s_cbranch_scc1 ac_f1last
    s_cmp_eq_u32 s34, 1
    s_cbranch_scc0 st_23
    buffer_store_dwordx4 v[144:147], v7, s[12:15], s21 offen offset:0 nt
    buffer_store_dwordx4 v[148:151], v7, s[12:15], s21 offen offset:1024 nt
st_24:
    s_waitcnt lgkmcnt(4)
.p2align 3
    v_pk_fma_f32 v[76:77], v[160:161], v[50:51], v[76:77] op_sel_hi:[1,0,1]
    v_pk_fma_f32 v[78:79], v[162:163], v[50:51], v[78:79] op_sel_hi:[1,0,1]
    v_pk_fma_f32 v[80:81], v[164:165], v[50:51], v[80:81] op_sel_hi:[1,0,1]
    v_pk_fma_f32 v[82:83], v[166:167], v[50:51], v[82:83] op_sel_hi:[1,0,1]
    v_pk_fma_f32 v[84:85], v[168:169], v[50:51], v[84:85] op_sel_hi:[1,0,1]
    v_pk_fma_f32 v[86:87], v[170:171], v[50:51], v[86:87] op_sel_hi:[1,0,1]
    v_pk_fma_f32 v[88:89], v[172:173], v[50:51], v[88:89] op_sel_hi:[1,0,1]
    v_pk_fma_f32 v[90:91], v[174:175], v[50:51], v[90:91] op_sel_hi:[1,0,1]
    v_pk_fma_f32 v[76:77], v[76:77], v[54:55], v[224:225] op_sel_hi:[1,0,1]
    v_pk_fma_f32 v[78:79], v[78:79], v[54:55], v[226:227] op_sel_hi:[1,0,1]
    v_pk_fma_f32 v[80:81], v[80:81], v[54:55], v[228:229] op_sel_hi:[1,0,1]
    v_pk_fma_f32 v[82:83], v[82:83], v[54:55], v[230:231] op_sel_hi:[1,0,1]
    v_pk_fma_f32 v[84:85], v[84:85], v[54:55], v[232:233] op_sel_hi:[1,0,1]
    v_pk_fma_f32 v[86:87], v[86:87], v[54:55], v[234:235] op_sel_hi:[1,0,1]
    v_pk_fma_f32 v[88:89], v[88:89], v[54:55], v[236:237] op_sel_hi:[1,0,1]
    v_pk_fma_f32 v[90:91], v[90:91], v[54:55], v[238:239] op_sel_hi:[1,0,1]
    v_exp_f32 v108, v76
    v_exp_f32 v109, v77
    v_exp_f32 v110, v78
    v_exp_f32 v111, v79
    v_exp_f32 v112, v80
    v_exp_f32 v113, v81
    v_exp_f32 v114, v82
    v_exp_f32 v115, v83
    v_exp_f32 v116, v84
    v_exp_f32 v117, v85
    v_exp_f32 v118, v86
    v_exp_f32 v119, v87
    v_exp_f32 v120, v88
    v_exp_f32 v121, v89
    v_exp_f32 v122, v90
    v_exp_f32 v123, v91
    v_pk_fma_f32 v[124:125], v[108:109], v[56:57], s[40:41] op_sel_hi:[1,0,1]
    v_pk_fma_f32 v[126:127], v[110:111], v[56:57], s[40:41] op_sel_hi:[1,0,1]
    v_pk_fma_f32 v[128:129], v[112:113], v[56:57], s[40:41] op_sel_hi:[1,0,1]
    v_pk_fma_f32 v[130:131], v[114:115], v[56:57], s[40:41] op_sel_hi:[1,0,1]
    v_pk_fma_f32 v[132:133], v[116:117], v[56:57], s[40:41] op_sel_hi:[1,0,1]
    v_pk_fma_f32 v[134:135], v[118:119], v[56:57], s[40:41] op_sel_hi:[1,0,1]
    v_pk_fma_f32 v[136:137], v[120:121], v[56:57], s[40:41] op_sel_hi:[1,0,1]
    v_pk_fma_f32 v[138:139], v[122:123], v[56:57], s[40:41] op_sel_hi:[1,0,1]
    v_pk_fma_f32 v[108:109], v[108:109], v[124:125], s[40:41]
    v_pk_fma_f32 v[110:111], v[110:111], v[126:127], s[40:41]
    v_pk_fma_f32 v[112:113], v[112:113], v[128:129], s[40:41]
    v_pk_fma_f32 v[114:115], v[114:115], v[130:131], s[40:41]
    v_pk_fma_f32 v[116:117], v[116:117], v[132:133], s[40:41]
    v_pk_fma_f32 v[118:119], v[118:119], v[134:135], s[40:41]
    v_pk_fma_f32 v[120:121], v[120:121], v[136:137], s[40:41]
    v_pk_fma_f32 v[122:123], v[122:123], v[138:139], s[40:41]
    v_rcp_f32 v108, v108
    v_rcp_f32 v109, v109
    v_rcp_f32 v110, v110
    v_rcp_f32 v111, v111
    v_rcp_f32 v112, v112
    v_rcp_f32 v113, v113
    v_rcp_f32 v114, v114
    v_rcp_f32 v115, v115
    v_rcp_f32 v116, v116
    v_rcp_f32 v117, v117
    v_rcp_f32 v118, v118
    v_rcp_f32 v119, v119
    v_rcp_f32 v120, v120
    v_rcp_f32 v121, v121
    v_rcp_f32 v122, v122
    v_rcp_f32 v123, v123
    v_pk_fma_f32 v[108:109], v[76:77], v[108:109], v[76:77] neg_lo:[1,0,0] neg_hi:[1,0,0]
    v_pk_fma_f32 v[110:111], v[78:79], v[110:111], v[78:79] neg_lo:[1,0,0] neg_hi:[1,0,0]
    v_pk_fma_f32 v[112:113], v[80:81], v[112:113], v[80:81] neg_lo:[1,0,0] neg_hi:[1,0,0]
    v_pk_fma_f32 v[114:115], v[82:83], v[114:115], v[82:83] neg_lo:[1,0,0] neg_hi:[1,0,0]
    v_pk_fma_f32 v[116:117], v[84:85], v[116:117], v[84:85] neg_lo:[1,0,0] neg_hi:[1,0,0]
    v_pk_fma_f32 v[118:119], v[86:87], v[118:119], v[86:87] neg_lo:[1,0,0] neg_hi:[1,0,0]
    v_pk_fma_f32 v[120:121], v[88:89], v[120:121], v[88:89] neg_lo:[1,0,0] neg_hi:[1,0,0]
    v_pk_fma_f32 v[122:123], v[90:91], v[122:123], v[90:91] neg_lo:[1,0,0] neg_hi:[1,0,0]
    v_cvt_pk_bf16_f32 v160, v108, v109
    v_cvt_pk_bf16_f32 v161, v110, v111
    v_cvt_pk_bf16_f32 v162, v112, v113
    v_cvt_pk_bf16_f32 v163, v114, v115
    v_cvt_pk_bf16_f32 v164, v116, v117
    v_cvt_pk_bf16_f32 v165, v118, v119
    v_cvt_pk_bf16_f32 v166, v120, v121
    v_cvt_pk_bf16_f32 v167, v122, v123
    s_cmp_eq_u32 s34, 1
    s_cbranch_scc0 st_25
    buffer_store_dwordx4 v[160:163], v7, s[12:15], s21 offen offset:2048 nt
    buffer_store_dwordx4 v[164:167], v7, s[12:15], s21 offen offset:3072 nt
st_26:
    s_waitcnt lgkmcnt(0)
.p2align 3
    v_pk_fma_f32 v[92:93], v[176:177], v[50:51], v[92:93] op_sel_hi:[1,0,1]
    v_pk_fma_f32 v[94:95], v[178:179], v[50:51], v[94:95] op_sel_hi:[1,0,1]
    v_pk_fma_f32 v[96:97], v[180:181], v[50:51], v[96:97] op_sel_hi:[1,0,1]
    v_pk_fma_f32 v[98:99], v[182:183], v[50:51], v[98:99] op_sel_hi:[1,0,1]
    v_pk_fma_f32 v[100:101], v[184:185], v[50:51], v[100:101] op_sel_hi:[1,0,1]
    v_pk_fma_f32 v[102:103], v[186:187], v[50:51], v[102:103] op_sel_hi:[1,0,1]
    v_pk_fma_f32 v[104:105], v[188:189], v[50:51], v[104:105] op_sel_hi:[1,0,1]
    v_pk_fma_f32 v[106:107], v[190:191], v[50:51], v[106:107] op_sel_hi:[1,0,1]
    v_pk_fma_f32 v[92:93], v[92:93], v[54:55], v[240:241] op_sel_hi:[1,0,1]
    v_pk_fma_f32 v[94:95], v[94:95], v[54:55], v[242:243] op_sel_hi:[1,0,1]
    v_pk_fma_f32 v[96:97], v[96:97], v[54:55], v[244:245] op_sel_hi:[1,0,1]
    v_pk_fma_f32 v[98:99], v[98:99], v[54:55], v[246:247] op_sel_hi:[1,0,1]
    v_pk_fma_f32 v[100:101], v[100:101], v[54:55], v[248:249] op_sel_hi:[1,0,1]
    v_pk_fma_f32 v[102:103], v[102:103], v[54:55], v[250:251] op_sel_hi:[1,0,1]
    v_pk_fma_f32 v[104:105], v[104:105], v[54:55], v[252:253] op_sel_hi:[1,0,1]
    v_pk_fma_f32 v[106:107], v[106:107], v[54:55], v[254:255] op_sel_hi:[1,0,1]
    v_exp_f32 v108, v92
    v_exp_f32 v109, v93
    v_exp_f32 v110, v94
    v_exp_f32 v111, v95
    v_exp_f32 v112, v96
    v_exp_f32 v113, v97
    v_exp_f32 v114, v98
    v_exp_f32 v115, v99
    v_exp_f32 v116, v100
    v_exp_f32 v117, v101
    v_exp_f32 v118, v102
    v_exp_f32 v119, v103
    v_exp_f32 v120, v104
    v_exp_f32 v121, v105
    v_exp_f32 v122, v106
    v_exp_f32 v123, v107
    v_pk_fma_f32 v[124:125], v[108:109], v[56:57], s[40:41] op_sel_hi:[1,0,1]
    v_pk_fma_f32 v[126:127], v[110:111], v[56:57], s[40:41] op_sel_hi:[1,0,1]
    v_pk_fma_f32 v[128:129], v[112:113], v[56:57], s[40:41] op_sel_hi:[1,0,1]
    v_pk_fma_f32 v[130:131], v[114:115], v[56:57], s[40:41] op_sel_hi:[1,0,1]
    v_pk_fma_f32 v[132:133], v[116:117], v[56:57], s[40:41] op_sel_hi:[1,0,1]
    v_pk_fma_f32 v[134:135], v[118:119], v[56:57], s[40:41] op_sel_hi:[1,0,1]
    v_pk_fma_f32 v[136:137], v[120:121], v[56:57], s[40:41] op_sel_hi:[1,0,1]
    v_pk_fma_f32 v[138:139], v[122:123], v[56:57], s[40:41] op_sel_hi:[1,0,1]
    v_pk_fma_f32 v[108:109], v[108:109], v[124:125], s[40:41]
    v_pk_fma_f32 v[110:111], v[110:111], v[126:127], s[40:41]
    v_pk_fma_f32 v[112:113], v[112:113], v[128:129], s[40:41]
    v_pk_fma_f32 v[114:115], v[114:115], v[130:131], s[40:41]
    v_pk_fma_f32 v[116:117], v[116:117], v[132:133], s[40:41]
    v_pk_fma_f32 v[118:119], v[118:119], v[134:135], s[40:41]
    v_pk_fma_f32 v[120:121], v[120:121], v[136:137], s[40:41]
    v_pk_fma_f32 v[122:123], v[122:123], v[138:139], s[40:41]
    v_rcp_f32 v108, v108
    v_rcp_f32 v109, v109
    v_rcp_f32 v110, v110
    v_rcp_f32 v111, v111
    v_rcp_f32 v112, v112
    v_rcp_f32 v113, v113
    v_rcp_f32 v114, v114
    v_rcp_f32 v115, v115
    v_rcp_f32 v116, v116
    v_rcp_f32 v117, v117
    v_rcp_f32 v118, v118
    v_rcp_f32 v119, v119
    v_rcp_f32 v120, v120
    v_rcp_f32 v121, v121
    v_rcp_f32 v122, v122
    v_rcp_f32 v123, v123
    v_pk_fma_f32 v[108:109], v[92:93], v[108:109], v[92:93] neg_lo:[1,0,0] neg_hi:[1,0,0]
    v_pk_fma_f32 v[110:111], v[94:95], v[110:111], v[94:95] neg_lo:[1,0,0] neg_hi:[1,0,0]
    v_pk_fma_f32 v[112:113], v[96:97], v[112:113], v[96:97] neg_lo:[1,0,0] neg_hi:[1,0,0]
    v_pk_fma_f32 v[114:115], v[98:99], v[114:115], v[98:99] neg_lo:[1,0,0] neg_hi:[1,0,0]
    v_pk_fma_f32 v[116:117], v[100:101], v[116:117], v[100:101] neg_lo:[1,0,0] neg_hi:[1,0,0]
    v_pk_fma_f32 v[118:119], v[102:103], v[118:119], v[102:103] neg_lo:[1,0,0] neg_hi:[1,0,0]
    v_pk_fma_f32 v[120:121], v[104:105], v[120:121], v[104:105] neg_lo:[1,0,0] neg_hi:[1,0,0]
    v_pk_fma_f32 v[122:123], v[106:107], v[122:123], v[106:107] neg_lo:[1,0,0] neg_hi:[1,0,0]
    v_cvt_pk_bf16_f32 v176, v108, v109
    v_cvt_pk_bf16_f32 v177, v110, v111
    v_cvt_pk_bf16_f32 v178, v112, v113
    v_cvt_pk_bf16_f32 v179, v114, v115
    v_cvt_pk_bf16_f32 v180, v116, v117
    v_cvt_pk_bf16_f32 v181, v118, v119
    v_cvt_pk_bf16_f32 v182, v120, v121
    v_cvt_pk_bf16_f32 v183, v122, v123
    s_cmp_eq_u32 s34, 1
    s_cbranch_scc0 st_27
    buffer_store_dwordx4 v[176:179], v7, s[12:15], s20 offen offset:0 nt
    buffer_store_dwordx4 v[180:183], v7, s[12:15], s20 offen offset:1024 nt
st_28:
ac_f1done:
    s_waitcnt lgkmcnt(0)
    s_waitcnt vmcnt(0)
    s_mov_b64 exec, 1
    s_cmp_eq_u32 s34, 1
    s_cbranch_scc0 st_29
    buffer_store_dword v11, off, s[12:15], s59 offset:256
st_30:
    s_mov_b64 exec, -1
    s_barrier
    ds_read_b64_tr_b16 v[108:109], v44 offset:24576
    ds_read_b64_tr_b16 v[110:111], v44 offset:25600
    ds_read_b64_tr_b16 v[112:113], v47 offset:24576
    ds_read_b64_tr_b16 v[114:115], v47 offset:25600
    ds_read_b64_tr_b16 v[116:117], v44 offset:26624
    ds_read_b64_tr_b16 v[118:119], v44 offset:27648
    ds_read_b64_tr_b16 v[120:121], v47 offset:26624
    ds_read_b64_tr_b16 v[122:123], v47 offset:27648
    s_mul_i32 s19, s24, 88064
    s_mul_i32 s5, s23, 44032
    s_add_u32 s19, s19, s5
    s_add_u32 s19, s19, 0xa00000
    v_lshlrev_b32 v208, 16, v24
    v_and_b32 v209, s42, v24
    v_lshlrev_b32 v210, 16, v25
    v_and_b32 v211, s42, v25
    v_lshlrev_b32 v212, 16, v26
    v_and_b32 v213, s42, v26
    v_lshlrev_b32 v214, 16, v27
    v_and_b32 v215, s42, v27
    v_lshlrev_b32 v216, 16, v28
    v_and_b32 v217, s42, v28
    v_lshlrev_b32 v218, 16, v29
    v_and_b32 v219, s42, v29
    v_lshlrev_b32 v220, 16, v30
    v_and_b32 v221, s42, v30
    v_lshlrev_b32 v222, 16, v31
    v_and_b32 v223, s42, v31
    s_mov_b32 s5, 0
poll_31:
    buffer_load_dword v32, v8, s[12:15], s35 offen offset:256 sc1
    s_add_u32 s5, s5, 1
    s_cmp_gt_u32 s5, 262144
    s_cbranch_scc1 polld_32
    s_waitcnt vmcnt(0)
    v_cmp_ne_u32 vcc, s100, v32
    s_and_b64 vcc, vcc, s[30:31]
    s_cbranch_scc1 poll_31
polld_32:
    buffer_load_dwordx4 v[144:147], v7, s[12:15], s19 offen offset:0 sc1
    buffer_load_dwordx4 v[148:151], v7, s[12:15], s19 offen offset:1024 sc1
    buffer_load_dwordx4 v[152:155], v7, s[12:15], s19 offen offset:2048 sc1
    buffer_load_dwordx4 v[156:159], v7, s[12:15], s19 offen offset:3072 sc1
    s_add_u32 s19, s19, 4096
    buffer_load_dwordx4 v[160:163], v7, s[12:15], s19 offen offset:0 sc1
    buffer_load_dwordx4 v[164:167], v7, s[12:15], s19 offen offset:1024 sc1
    buffer_load_dwordx4 v[168:171], v7, s[12:15], s19 offen offset:2048 sc1
    s_waitcnt vmcnt(6) lgkmcnt(4)
    v_mfma_f32_32x32x16_bf16 v[76:91], v[112:115], v[144:147], 0
    ds_read_b64_tr_b16 v[128:129], v47 offset:28672
    ds_read_b64_tr_b16 v[130:131], v47 offset:29696
    buffer_load_dwordx4 v[172:175], v7, s[12:15], s19 offen offset:3072 sc1
    s_add_u32 s19, s19, 4096
    v_mfma_f32_32x32x16_bf16 v[60:75], v[108:111], v[144:147], 0
    ds_read_b64_tr_b16 v[124:125], v44 offset:28672
    ds_read_b64_tr_b16 v[126:127], v44 offset:29696
    s_waitcnt vmcnt(6) lgkmcnt(4)
    v_mfma_f32_32x32x16_bf16 v[76:91], v[120:123], v[148:151], v[76:91]
    ds_read_b64_tr_b16 v[112:113], v47 offset:30720
    ds_read_b64_tr_b16 v[114:115], v47 offset:31744
    buffer_load_dwordx4 v[176:179], v7, s[12:15], s19 offen offset:0 sc1
    v_mfma_f32_32x32x16_bf16 v[60:75], v[116:119], v[148:151], v[60:75]
    ds_read_b64_tr_b16 v[108:109], v44 offset:30720
    ds_read_b64_tr_b16 v[110:111], v44 offset:31744
    s_waitcnt vmcnt(6) lgkmcnt(4)
    v_mfma_f32_32x32x16_bf16 v[76:91], v[128:131], v[152:155], v[76:91]
    ds_read_b64_tr_b16 v[120:121], v47 offset:40960
    ds_read_b64_tr_b16 v[122:123], v47 offset:41984
    buffer_load_dwordx4 v[180:183], v7, s[12:15], s19 offen offset:1024 sc1
    v_mfma_f32_32x32x16_bf16 v[60:75], v[124:127], v[152:155], v[60:75]
    ds_read_b64_tr_b16 v[116:117], v44 offset:40960
    ds_read_b64_tr_b16 v[118:119], v44 offset:41984
    s_waitcnt vmcnt(6) lgkmcnt(4)
    v_mfma_f32_32x32x16_bf16 v[76:91], v[112:115], v[156:159], v[76:91]
    ds_read_b64_tr_b16 v[128:129], v47 offset:43008
    ds_read_b64_tr_b16 v[130:131], v47 offset:44032
    buffer_load_dwordx4 v[184:187], v7, s[12:15], s19 offen offset:2048 sc1
    v_mfma_f32_32x32x16_bf16 v[60:75], v[108:111], v[156:159], v[60:75]
    ds_read_b64_tr_b16 v[124:125], v44 offset:43008
    ds_read_b64_tr_b16 v[126:127], v44 offset:44032
    s_waitcnt vmcnt(6) lgkmcnt(4)
    v_mfma_f32_32x32x16_bf16 v[76:91], v[120:123], v[160:163], v[76:91]
    ds_read_b64_tr_b16 v[112:113], v47 offset:45056
    ds_read_b64_tr_b16 v[114:115], v47 offset:46080
    buffer_load_dwordx4 v[188:191], v7, s[12:15], s19 offen offset:3072 sc1
    s_add_u32 s19, s19, 4096
    v_mfma_f32_32x32x16_bf16 v[60:75], v[116:119], v[160:163], v[60:75]
    ds_read_b64_tr_b16 v[108:109], v44 offset:45056
    ds_read_b64_tr_b16 v[110:111], v44 offset:46080
    s_waitcnt vmcnt(6) lgkmcnt(4)
    v_mfma_f32_32x32x16_bf16 v[76:91], v[128:131], v[164:167], v[76:91]
    ds_read_b64_tr_b16 v[120:121], v47 offset:47104
    ds_read_b64_tr_b16 v[122:123], v47 offset:48128
    buffer_load_dwordx4 v[192:195], v7, s[12:15], s19 offen offset:0 sc1
    v_mfma_f32_32x32x16_bf16 v[60:75], v[124:127], v[164:167], v[60:75]
    ds_read_b64_tr_b16 v[116:117], v44 offset:47104
    ds_read_b64_tr_b16 v[118:119], v44 offset:48128
    s_waitcnt vmcnt(6) lgkmcnt(4)
    v_mfma_f32_32x32x16_bf16 v[76:91], v[112:115], v[168:171], v[76:91]
    ds_read_b64_tr_b16 v[128:129], v49 offset:8192
    ds_read_b64_tr_b16 v[130:131], v49 offset:9216
    buffer_load_dwordx4 v[196:199], v7, s[12:15], s19 offen offset:1024 sc1
    v_mfma_f32_32x32x16_bf16 v[60:75], v[108:111], v[168:171], v[60:75]
    ds_read_b64_tr_b16 v[124:125], v46 offset:8192
    ds_read_b64_tr_b16 v[126:127], v46 offset:9216
    s_waitcnt vmcnt(6) lgkmcnt(4)
    v_mfma_f32_32x32x16_bf16 v[76:91], v[120:123], v[172:175], v[76:91]
    ds_read_b64_tr_b16 v[112:113], v49 offset:10240
    ds_read_b64_tr_b16 v[114:115], v49 offset:11264
    buffer_load_dwordx4 v[200:203], v7, s[12:15], s19 offen offset:2048 sc1
    v_mfma_f32_32x32x16_bf16 v[60:75], v[116:119], v[172:175], v[60:75]
    ds_read_b64_tr_b16 v[108:109], v46 offset:10240
    ds_read_b64_tr_b16 v[110:111], v46 offset:11264
    s_waitcnt vmcnt(6) lgkmcnt(4)
    v_mfma_f32_32x32x16_bf16 v[76:91], v[128:131], v[176:179], v[76:91]
    ds_read_b64_tr_b16 v[120:121], v49 offset:12288
    ds_read_b64_tr_b16 v[122:123], v49 offset:13312
    buffer_load_dwordx4 v[204:207], v7, s[12:15], s19 offen offset:3072 sc1
    s_add_u32 s19, s19, 4096
    v_mfma_f32_32x32x16_bf16 v[60:75], v[124:127], v[176:179], v[60:75]
    ds_read_b64_tr_b16 v[116:117], v46 offset:12288
    ds_read_b64_tr_b16 v[118:119], v46 offset:13312
    s_waitcnt vmcnt(6) lgkmcnt(4)
    v_mfma_f32_32x32x16_bf16 v[76:91], v[112:115], v[180:183], v[76:91]
    ds_read_b64_tr_b16 v[128:129], v49 offset:14336
    ds_read_b64_tr_b16 v[130:131], v49 offset:15360
    buffer_load_dwordx4 v[144:147], v7, s[12:15], s19 offen offset:0 sc1
    v_mfma_f32_32x32x16_bf16 v[60:75], v[108:111], v[180:183], v[60:75]
    ds_read_b64_tr_b16 v[124:125], v46 offset:14336
    ds_read_b64_tr_b16 v[126:127], v46 offset:15360
    s_waitcnt vmcnt(6) lgkmcnt(4)
    v_mfma_f32_32x32x16_bf16 v[76:91], v[120:123], v[184:187], v[76:91]
    ds_read_b64_tr_b16 v[112:113], v47 offset:57344
    ds_read_b64_tr_b16 v[114:115], v47 offset:58368
    buffer_load_dwordx4 v[148:151], v7, s[12:15], s19 offen offset:1024 sc1
    v_mfma_f32_32x32x16_bf16 v[60:75], v[116:119], v[184:187], v[60:75]
    ds_read_b64_tr_b16 v[108:109], v44 offset:57344
    ds_read_b64_tr_b16 v[110:111], v44 offset:58368
    s_waitcnt vmcnt(6) lgkmcnt(4)
    v_mfma_f32_32x32x16_bf16 v[76:91], v[128:131], v[188:191], v[76:91]
    ds_read_b64_tr_b16 v[120:121], v47 offset:59392
    ds_read_b64_tr_b16 v[122:123], v47 offset:60416
    buffer_load_dwordx4 v[152:155], v7, s[12:15], s19 offen offset:2048 sc1
    v_mfma_f32_32x32x16_bf16 v[60:75], v[124:127], v[188:191], v[60:75]
    ds_read_b64_tr_b16 v[116:117], v44 offset:59392
    ds_read_b64_tr_b16 v[118:119], v44 offset:60416
    s_barrier
    s_waitcnt vmcnt(6) lgkmcnt(4)
    v_mfma_f32_32x32x16_bf16 v[76:91], v[112:115], v[192:195], v[76:91]
    ds_read_b64_tr_b16 v[128:129], v47 offset:61440
    ds_read_b64_tr_b16 v[130:131], v47 offset:62464
    buffer_load_dwordx4 v[156:159], v7, s[12:15], s19 offen offset:3072 sc1
    s_add_u32 s19, s19, 4096
    v_mfma_f32_32x32x16_bf16 v[60:75], v[108:111], v[192:195], v[60:75]
    ds_read_b64_tr_b16 v[124:125], v44 offset:61440
    ds_read_b64_tr_b16 v[126:127], v44 offset:62464
    s_waitcnt vmcnt(6) lgkmcnt(4)
    v_mfma_f32_32x32x16_bf16 v[76:91], v[120:123], v[196:199], v[76:91]
    ds_read_b64_tr_b16 v[112:113], v47 offset:63488
    ds_read_b64_tr_b16 v[114:115], v47 offset:64512
    buffer_load_dwordx4 v[160:163], v7, s[12:15], s19 offen offset:0 sc1
    v_mfma_f32_32x32x16_bf16 v[60:75], v[116:119], v[196:199], v[60:75]
    ds_read_b64_tr_b16 v[108:109], v44 offset:63488
    ds_read_b64_tr_b16 v[110:111], v44 offset:64512
    s_waitcnt vmcnt(6) lgkmcnt(4)
    v_mfma_f32_32x32x16_bf16 v[76:91], v[128:131], v[200:203], v[76:91]
    ds_read_b64_tr_b16 v[120:121], v48 offset:8192
    ds_read_b64_tr_b16 v[122:123], v48 offset:9216
    buffer_load_dwordx4 v[164:167], v7, s[12:15], s19 offen offset:1024 sc1
    v_mfma_f32_32x32x16_bf16 v[60:75], v[124:127], v[200:203], v[60:75]
    ds_read_b64_tr_b16 v[116:117], v45 offset:8192
    ds_read_b64_tr_b16 v[118:119], v45 offset:9216
    s_waitcnt vmcnt(6) lgkmcnt(4)
    v_mfma_f32_32x32x16_bf16 v[76:91], v[112:115], v[204:207], v[76:91]
    ds_read_b64_tr_b16 v[128:129], v48 offset:10240
    ds_read_b64_tr_b16 v[130:131], v48 offset:11264
    buffer_load_dwordx4 v[168:171], v7, s[12:15], s19 offen offset:2048 sc1
    v_mfma_f32_32x32x16_bf16 v[60:75], v[108:111], v[204:207], v[60:75]
    ds_read_b64_tr_b16 v[124:125], v45 offset:10240
    ds_read_b64_tr_b16 v[126:127], v45 offset:11264
    s_waitcnt vmcnt(6) lgkmcnt(4)
    v_mfma_f32_32x32x16_bf16 v[76:91], v[120:123], v[144:147], v[76:91]
    ds_read_b64_tr_b16 v[112:113], v48 offset:12288
    ds_read_b64_tr_b16 v[114:115], v48 offset:13312
    buffer_load_dwordx4 v[172:175], v7, s[12:15], s19 offen offset:3072 sc1
    s_add_u32 s19, s19, 4096
    v_mfma_f32_32x32x16_bf16 v[60:75], v[116:119], v[144:147], v[60:75]
    ds_read_b64_tr_b16 v[108:109], v45 offset:12288
    ds_read_b64_tr_b16 v[110:111], v45 offset:13312
    s_waitcnt vmcnt(6) lgkmcnt(4)
    v_mfma_f32_32x32x16_bf16 v[76:91], v[128:131], v[148:151], v[76:91]
    ds_read_b64_tr_b16 v[120:121], v48 offset:14336
    ds_read_b64_tr_b16 v[122:123], v48 offset:15360
    buffer_load_dwordx4 v[176:179], v7, s[12:15], s19 offen offset:0 sc1
    v_mfma_f32_32x32x16_bf16 v[60:75], v[124:127], v[148:151], v[60:75]
    ds_read_b64_tr_b16 v[116:117], v45 offset:14336
    ds_read_b64_tr_b16 v[118:119], v45 offset:15360
    s_waitcnt vmcnt(6) lgkmcnt(4)
    v_mfma_f32_32x32x16_bf16 v[76:91], v[112:115], v[152:155], v[76:91]
    ds_read_b64_tr_b16 v[128:129], v48 offset:24576
    ds_read_b64_tr_b16 v[130:131], v48 offset:25600
    buffer_load_dwordx4 v[180:183], v7, s[12:15], s19 offen offset:1024 sc1
    v_mfma_f32_32x32x16_bf16 v[60:75], v[108:111], v[152:155], v[60:75]
    ds_read_b64_tr_b16 v[124:125], v45 offset:24576
    ds_read_b64_tr_b16 v[126:127], v45 offset:25600
    s_waitcnt vmcnt(6) lgkmcnt(4)
    v_mfma_f32_32x32x16_bf16 v[76:91], v[120:123], v[156:159], v[76:91]
    ds_read_b64_tr_b16 v[112:113], v48 offset:26624
    ds_read_b64_tr_b16 v[114:115], v48 offset:27648
    buffer_load_dwordx4 v[184:187], v7, s[12:15], s19 offen offset:2048 sc1
    v_mfma_f32_32x32x16_bf16 v[60:75], v[116:119], v[156:159], v[60:75]
    ds_read_b64_tr_b16 v[108:109], v45 offset:26624
    ds_read_b64_tr_b16 v[110:111], v45 offset:27648
    s_waitcnt vmcnt(6) lgkmcnt(4)
    v_mfma_f32_32x32x16_bf16 v[76:91], v[128:131], v[160:163], v[76:91]
    ds_read_b64_tr_b16 v[120:121], v48 offset:28672
    ds_read_b64_tr_b16 v[122:123], v48 offset:29696
    buffer_load_dwordx4 v[188:191], v7, s[12:15], s19 offen offset:3072 sc1
    s_add_u32 s19, s19, 4096
    v_mfma_f32_32x32x16_bf16 v[60:75], v[124:127], v[160:163], v[60:75]
    ds_read_b64_tr_b16 v[116:117], v45 offset:28672
    ds_read_b64_tr_b16 v[118:119], v45 offset:29696
    s_waitcnt vmcnt(6) lgkmcnt(4)
    v_mfma_f32_32x32x16_bf16 v[76:91], v[112:115], v[164:167], v[76:91]
    ds_read_b64_tr_b16 v[128:129], v48 offset:30720
    ds_read_b64_tr_b16 v[130:131], v48 offset:31744
    buffer_load_dwordx4 v[192:195], v7, s[12:15], s19 offen offset:0 sc1
    v_mfma_f32_32x32x16_bf16 v[60:75], v[108:111], v[164:167], v[60:75]
    ds_read_b64_tr_b16 v[124:125], v45 offset:30720
    ds_read_b64_tr_b16 v[126:127], v45 offset:31744
    s_waitcnt vmcnt(6) lgkmcnt(4)
    v_mfma_f32_32x32x16_bf16 v[76:91], v[120:123], v[168:171], v[76:91]
    ds_read_b64_tr_b16 v[112:113], v48 offset:40960
    ds_read_b64_tr_b16 v[114:115], v48 offset:41984
    buffer_load_dwordx4 v[196:199], v7, s[12:15], s19 offen offset:1024 sc1
    v_mfma_f32_32x32x16_bf16 v[60:75], v[116:119], v[168:171], v[60:75]
    ds_read_b64_tr_b16 v[108:109], v45 offset:40960
    ds_read_b64_tr_b16 v[110:111], v45 offset:41984
    s_waitcnt vmcnt(6) lgkmcnt(4)
    v_mfma_f32_32x32x16_bf16 v[76:91], v[128:131], v[172:175], v[76:91]
    ds_read_b64_tr_b16 v[120:121], v48 offset:43008
    ds_read_b64_tr_b16 v[122:123], v48 offset:44032
    buffer_load_dwordx4 v[200:203], v7, s[12:15], s19 offen offset:2048 sc1
    v_mfma_f32_32x32x16_bf16 v[60:75], v[124:127], v[172:175], v[60:75]
    ds_read_b64_tr_b16 v[116:117], v45 offset:43008
    ds_read_b64_tr_b16 v[118:119], v45 offset:44032
    s_waitcnt vmcnt(6) lgkmcnt(4)
    v_mfma_f32_32x32x16_bf16 v[76:91], v[112:115], v[176:179], v[76:91]
    ds_read_b64_tr_b16 v[128:129], v48 offset:45056
    ds_read_b64_tr_b16 v[130:131], v48 offset:46080
    buffer_load_dwordx4 v[204:207], v7, s[12:15], s19 offen offset:3072 sc1
    s_add_u32 s19, s19, 4096
    v_mfma_f32_32x32x16_bf16 v[60:75], v[108:111], v[176:179], v[60:75]
    ds_read_b64_tr_b16 v[124:125], v45 offset:45056
    ds_read_b64_tr_b16 v[126:127], v45 offset:46080
    s_waitcnt vmcnt(6) lgkmcnt(4)
    v_mfma_f32_32x32x16_bf16 v[76:91], v[120:123], v[180:183], v[76:91]
    ds_read_b64_tr_b16 v[112:113], v48 offset:47104
    ds_read_b64_tr_b16 v[114:115], v48 offset:48128
    buffer_load_dwordx4 v[144:147], v7, s[12:15], s19 offen offset:0 sc1
    v_mfma_f32_32x32x16_bf16 v[60:75], v[116:119], v[180:183], v[60:75]
    ds_read_b64_tr_b16 v[108:109], v45 offset:47104
    ds_read_b64_tr_b16 v[110:111], v45 offset:48128
    s_waitcnt vmcnt(6) lgkmcnt(4)
    v_mfma_f32_32x32x16_bf16 v[76:91], v[128:131], v[184:187], v[76:91]
    ds_read_b64_tr_b16 v[120:121], v48 offset:57344
    ds_read_b64_tr_b16 v[122:123], v48 offset:58368
    buffer_load_dwordx4 v[148:151], v7, s[12:15], s19 offen offset:1024 sc1
    v_mfma_f32_32x32x16_bf16 v[60:75], v[124:127], v[184:187], v[60:75]
    ds_read_b64_tr_b16 v[116:117], v45 offset:57344
    ds_read_b64_tr_b16 v[118:119], v45 offset:58368
    s_waitcnt vmcnt(6) lgkmcnt(4)
    v_mfma_f32_32x32x16_bf16 v[76:91], v[112:115], v[188:191], v[76:91]
    ds_read_b64_tr_b16 v[128:129], v48 offset:59392
    ds_read_b64_tr_b16 v[130:131], v48 offset:60416
    buffer_load_dwordx4 v[152:155], v7, s[12:15], s19 offen offset:2048 sc1
    v_mfma_f32_32x32x16_bf16 v[60:75], v[108:111], v[188:191], v[60:75]
    ds_read_b64_tr_b16 v[124:125], v45 offset:59392
    ds_read_b64_tr_b16 v[126:127], v45 offset:60416
    s_waitcnt vmcnt(6) lgkmcnt(4)
    v_mfma_f32_32x32x16_bf16 v[76:91], v[120:123], v[192:195], v[76:91]
    ds_read_b64_tr_b16 v[112:113], v48 offset:61440
    ds_read_b64_tr_b16 v[114:115], v48 offset:62464
    buffer_load_dwordx4 v[156:159], v7, s[12:15], s19 offen offset:3072 sc1
    s_add_u32 s19, s19, 4096
    v_mfma_f32_32x32x16_bf16 v[60:75], v[116:119], v[192:195], v[60:75]
    ds_read_b64_tr_b16 v[108:109], v45 offset:61440
    ds_read_b64_tr_b16 v[110:111], v45 offset:62464
    s_waitcnt vmcnt(6) lgkmcnt(4)
    v_mfma_f32_32x32x16_bf16 v[76:91], v[128:131], v[196:199], v[76:91]
    ds_read_b64_tr_b16 v[120:121], v48 offset:63488
    ds_read_b64_tr_b16 v[122:123], v48 offset:64512
    buffer_load_dwordx4 v[160:163], v7, s[12:15], s19 offen offset:0 sc1
    v_mfma_f32_32x32x16_bf16 v[60:75], v[124:127], v[196:199], v[60:75]
    ds_read_b64_tr_b16 v[116:117], v45 offset:63488
    ds_read_b64_tr_b16 v[118:119], v45 offset:64512
    s_waitcnt vmcnt(6) lgkmcnt(4)
    v_mfma_f32_32x32x16_bf16 v[76:91], v[112:115], v[200:203], v[76:91]
    ds_read_b64_tr_b16 v[128:129], v47 offset:0
    ds_read_b64_tr_b16 v[130:131], v47 offset:1024
    buffer_load_dwordx4 v[164:167], v7, s[12:15], s19 offen offset:1024 sc1
    v_mfma_f32_32x32x16_bf16 v[60:75], v[108:111], v[200:203], v[60:75]
    ds_read_b64_tr_b16 v[124:125], v44 offset:0
    ds_read_b64_tr_b16 v[126:127], v44 offset:1024
    s_waitcnt vmcnt(6) lgkmcnt(4)
    v_mfma_f32_32x32x16_bf16 v[76:91], v[120:123], v[204:207], v[76:91]
    ds_read_b64_tr_b16 v[112:113], v47 offset:2048
    ds_read_b64_tr_b16 v[114:115], v47 offset:3072
    buffer_load_dwordx4 v[168:171], v7, s[12:15], s19 offen offset:2048 sc1
    v_mfma_f32_32x32x16_bf16 v[60:75], v[116:119], v[204:207], v[60:75]
    ds_read_b64_tr_b16 v[108:109], v44 offset:2048
    ds_read_b64_tr_b16 v[110:111], v44 offset:3072
    s_waitcnt vmcnt(6) lgkmcnt(4)
    v_mfma_f32_32x32x16_bf16 v[76:91], v[128:131], v[144:147], v[76:91]
    ds_read_b64_tr_b16 v[120:121], v47 offset:4096
    ds_read_b64_tr_b16 v[122:123], v47 offset:5120
    buffer_load_dwordx4 v[172:175], v7, s[12:15], s19 offen offset:3072 sc1
    s_add_u32 s19, s19, 4096
    v_mfma_f32_32x32x16_bf16 v[60:75], v[124:127], v[144:147], v[60:75]
    ds_read_b64_tr_b16 v[116:117], v44 offset:4096
    ds_read_b64_tr_b16 v[118:119], v44 offset:5120
    s_waitcnt vmcnt(6) lgkmcnt(4)
    v_mfma_f32_32x32x16_bf16 v[76:91], v[112:115], v[148:151], v[76:91]
    ds_read_b64_tr_b16 v[128:129], v47 offset:6144
    ds_read_b64_tr_b16 v[130:131], v47 offset:7168
    buffer_load_dwordx4 v[176:179], v7, s[12:15], s19 offen offset:0 sc1
    v_mfma_f32_32x32x16_bf16 v[60:75], v[108:111], v[148:151], v[60:75]
    ds_read_b64_tr_b16 v[124:125], v44 offset:6144
    ds_read_b64_tr_b16 v[126:127], v44 offset:7168
    s_waitcnt lgkmcnt(0)
    s_barrier
    s_waitcnt vmcnt(6) lgkmcnt(4)
    v_mfma_f32_32x32x16_bf16 v[76:91], v[120:123], v[152:155], v[76:91]
    ds_read_b64_tr_b16 v[112:113], v47 offset:16384
    ds_read_b64_tr_b16 v[114:115], v47 offset:17408
    buffer_load_dwordx4 v[180:183], v7, s[12:15], s19 offen offset:1024 sc1
    v_mfma_f32_32x32x16_bf16 v[60:75], v[116:119], v[152:155], v[60:75]
    ds_read_b64_tr_b16 v[108:109], v44 offset:16384
    ds_read_b64_tr_b16 v[110:111], v44 offset:17408
    s_waitcnt vmcnt(6) lgkmcnt(4)
    v_mfma_f32_32x32x16_bf16 v[76:91], v[128:131], v[156:159], v[76:91]
    ds_read_b64_tr_b16 v[120:121], v47 offset:18432
    ds_read_b64_tr_b16 v[122:123], v47 offset:19456
    buffer_load_dwordx4 v[184:187], v7, s[12:15], s19 offen offset:2048 sc1
    v_mfma_f32_32x32x16_bf16 v[60:75], v[124:127], v[156:159], v[60:75]
    ds_read_b64_tr_b16 v[116:117], v44 offset:18432
    ds_read_b64_tr_b16 v[118:119], v44 offset:19456
    s_waitcnt vmcnt(6) lgkmcnt(4)
    v_mfma_f32_32x32x16_bf16 v[76:91], v[112:115], v[160:163], v[76:91]
    ds_read_b64_tr_b16 v[128:129], v47 offset:20480
    ds_read_b64_tr_b16 v[130:131], v47 offset:21504
    v_mfma_f32_32x32x16_bf16 v[60:75], v[108:111], v[160:163], v[60:75]
    ds_read_b64_tr_b16 v[124:125], v44 offset:20480
    ds_read_b64_tr_b16 v[126:127], v44 offset:21504
    s_waitcnt vmcnt(5) lgkmcnt(4)
    v_mfma_f32_32x32x16_bf16 v[76:91], v[120:123], v[164:167], v[76:91]
    ds_read_b64_tr_b16 v[112:113], v47 offset:22528
    ds_read_b64_tr_b16 v[114:115], v47 offset:23552
    v_mfma_f32_32x32x16_bf16 v[60:75], v[116:119], v[164:167], v[60:75]
    ds_read_b64_tr_b16 v[108:109], v44 offset:22528
    ds_read_b64_tr_b16 v[110:111], v44 offset:23552
    s_waitcnt vmcnt(4) lgkmcnt(4)
    v_mfma_f32_32x32x16_bf16 v[76:91], v[128:131], v[168:171], v[76:91]
    ds_read_b64_tr_b16 v[120:121], v47 offset:32768
    ds_read_b64_tr_b16 v[122:123], v47 offset:33792
    v_mfma_f32_32x32x16_bf16 v[60:75], v[124:127], v[168:171], v[60:75]
    ds_read_b64_tr_b16 v[116:117], v44 offset:32768
    ds_read_b64_tr_b16 v[118:119], v44 offset:33792
    s_waitcnt vmcnt(3) lgkmcnt(4)
    v_mfma_f32_32x32x16_bf16 v[76:91], v[112:115], v[172:175], v[76:91]
    ds_read_b64_tr_b16 v[128:129], v47 offset:34816
    ds_read_b64_tr_b16 v[130:131], v47 offset:35840
    v_mfma_f32_32x32x16_bf16 v[60:75], v[108:111], v[172:175], v[60:75]
    ds_read_b64_tr_b16 v[124:125], v44 offset:34816
    ds_read_b64_tr_b16 v[126:127], v44 offset:35840
    s_waitcnt vmcnt(2) lgkmcnt(4)
    v_mfma_f32_32x32x16_bf16 v[76:91], v[120:123], v[176:179], v[76:91]
    ds_read_b64_tr_b16 v[112:113], v47 offset:36864
    ds_read_b64_tr_b16 v[114:115], v47 offset:37888
    v_mfma_f32_32x32x16_bf16 v[60:75], v[116:119], v[176:179], v[60:75]
    ds_read_b64_tr_b16 v[108:109], v44 offset:36864
    ds_read_b64_tr_b16 v[110:111], v44 offset:37888
    s_waitcnt vmcnt(1) lgkmcnt(4)
    v_mfma_f32_32x32x16_bf16 v[76:91], v[128:131], v[180:183], v[76:91]
    v_mfma_f32_32x32x16_bf16 v[60:75], v[124:127], v[180:183], v[60:75]
    s_waitcnt vmcnt(0) lgkmcnt(0)
    v_mfma_f32_32x32x16_bf16 v[76:91], v[112:115], v[184:187], v[76:91]
    v_mfma_f32_32x32x16_bf16 v[60:75], v[108:111], v[184:187], v[60:75]
    s_mov_b32 s40, 0x3f317218
    s_mov_b32 s41, s40
    s_nop 8
    ds_write_b128 v34, v[76:79] offset:0
    ds_write_b128 v34, v[80:83] offset:1024
    ds_write_b128 v34, v[84:87] offset:2048
    ds_write_b128 v34, v[88:91] offset:3072
    v_pk_fma_f32 v[60:61], v[60:61], s[40:41], v[208:209]
    v_pk_fma_f32 v[62:63], v[62:63], s[40:41], v[210:211]
    v_pk_fma_f32 v[64:65], v[64:65], s[40:41], v[212:213]
    v_pk_fma_f32 v[66:67], v[66:67], s[40:41], v[214:215]
    v_pk_fma_f32 v[68:69], v[68:69], s[40:41], v[216:217]
    v_pk_fma_f32 v[70:71], v[70:71], s[40:41], v[218:219]
    v_pk_fma_f32 v[72:73], v[72:73], s[40:41], v[220:221]
    v_pk_fma_f32 v[74:75], v[74:75], s[40:41], v[222:223]
    s_waitcnt lgkmcnt(0)
    s_barrier
    ds_read_b128 v[76:79], v35 offset:0
    ds_read_b128 v[80:83], v35 offset:1024
    ds_read_b128 v[84:87], v35 offset:2048
    ds_read_b128 v[88:91], v35 offset:3072
    s_waitcnt lgkmcnt(3)
    v_pk_fma_f32 v[60:61], v[76:77], s[40:41], v[60:61]
    v_pk_fma_f32 v[62:63], v[78:79], s[40:41], v[62:63]
    s_waitcnt lgkmcnt(2)
    v_pk_fma_f32 v[64:65], v[80:81], s[40:41], v[64:65]
    v_pk_fma_f32 v[66:67], v[82:83], s[40:41], v[66:67]
    s_waitcnt lgkmcnt(1)
    v_pk_fma_f32 v[68:69], v[84:85], s[40:41], v[68:69]
    v_pk_fma_f32 v[70:71], v[86:87], s[40:41], v[70:71]
    s_waitcnt lgkmcnt(0)
    v_pk_fma_f32 v[72:73], v[88:89], s[40:41], v[72:73]
    v_pk_fma_f32 v[74:75], v[90:91], s[40:41], v[74:75]
    v_cvt_pk_bf16_f32 v24, v60, v61
    v_cvt_pk_bf16_f32 v25, v62, v63
    v_cvt_pk_bf16_f32 v26, v64, v65
    v_cvt_pk_bf16_f32 v27, v66, v67
    v_cvt_pk_bf16_f32 v28, v68, v69
    v_cvt_pk_bf16_f32 v29, v70, v71
    v_cvt_pk_bf16_f32 v30, v72, v73
    v_cvt_pk_bf16_f32 v31, v74, v75
    s_cmp_eq_u32 s101, 1
    s_cbranch_scc1 ac_final
    s_cmp_eq_u32 s34, 1
    s_cbranch_scc0 st_33
    buffer_store_dwordx4 v[24:27], v7, s[12:15], s26 offen nt
    buffer_store_dwordx4 v[28:31], v7, s[12:15], s26 offen offset:1024 nt
st_34:
    v_pk_add_f32 v[56:57], v[60:61], v[62:63]
    v_pk_mul_f32 v[58:59], v[60:61], v[60:61]
    v_pk_add_f32 v[76:77], v[64:65], v[66:67]
    v_pk_mul_f32 v[78:79], v[62:63], v[62:63]
    v_pk_fma_f32 v[58:59], v[64:65], v[64:65], v[58:59]
    v_pk_fma_f32 v[78:79], v[66:67], v[66:67], v[78:79]
    v_pk_add_f32 v[56:57], v[56:57], v[68:69]
    v_pk_fma_f32 v[58:59], v[68:69], v[68:69], v[58:59]
    v_pk_add_f32 v[76:77], v[76:77], v[70:71]
    v_pk_fma_f32 v[78:79], v[70:71], v[70:71], v[78:79]
    v_pk_add_f32 v[56:57], v[56:57], v[72:73]
    v_pk_fma_f32 v[58:59], v[72:73], v[72:73], v[58:59]
    v_pk_add_f32 v[76:77], v[76:77], v[74:75]
    v_pk_fma_f32 v[78:79], v[74:75], v[74:75], v[78:79]
    v_pk_add_f32 v[56:57], v[56:57], v[76:77]
    v_pk_add_f32 v[58:59], v[58:59], v[78:79]
    v_add_f32 v56, v56, v57
    v_add_f32 v58, v58, v59
    s_nop 1
    v_permlane32_swap_b32 v56, v58
    s_nop 1
    v_add_f32 v56, v56, v58
    s_cmp_eq_u32 s34, 1
    s_cbranch_scc0 st_35
    buffer_store_dword v56, v36, s[12:15], s27 offen
st_36:
    s_waitcnt vmcnt(0)
    s_mov_b64 exec, 1
    s_cmp_eq_u32 s34, 1
    s_cbranch_scc0 st_37
    buffer_store_dword v11, off, s[12:15], s59 offset:512
st_38:
    s_mov_b64 exec, -1
    s_barrier
    ds_read_b64_tr_b16 v[108:109], v43 offset:8192
    ds_read_b64_tr_b16 v[110:111], v43 offset:9728
    ds_read_b64_tr_b16 v[112:113], v43 offset:8256
    ds_read_b64_tr_b16 v[114:115], v43 offset:9792
    ds_read_b64_tr_b16 v[116:117], v43 offset:8320
    ds_read_b64_tr_b16 v[118:119], v43 offset:9856
    ds_read_b64_tr_b16 v[120:121], v43 offset:11264
    ds_read_b64_tr_b16 v[122:123], v43 offset:12800
    ds_read_b64_tr_b16 v[124:125], v43 offset:11328
    ds_read_b64_tr_b16 v[126:127], v43 offset:12864
    ds_read_b64_tr_b16 v[128:129], v43 offset:11392
    ds_read_b64_tr_b16 v[130:131], v43 offset:12928
    s_lshl_b32 s19, s57, 15
    s_lshl_b32 s20, s57, 12
    s_add_u32 s20, s20, 0x1000000
    s_mov_b32 s5, 0
poll_39:
    buffer_load_dword v32, v8, s[12:15], s35 offen offset:512 sc1
    s_add_u32 s5, s5, 1
    s_cmp_gt_u32 s5, 262144
    s_cbranch_scc1 polld_40
    s_waitcnt vmcnt(0)
    v_cmp_ne_u32 vcc, s100, v32
    s_and_b64 vcc, vcc, s[28:29]
    s_cbranch_scc1 poll_39
polld_40:
    buffer_load_dwordx4 v[144:147], v7, s[12:15], s19 offen offset:0 sc1
    buffer_load_dwordx4 v[148:151], v7, s[12:15], s19 offen offset:1024 sc1
    buffer_load_dwordx4 v[152:155], v7, s[12:15], s19 offen offset:2048 sc1
    buffer_load_dwordx4 v[156:159], v7, s[12:15], s19 offen offset:3072 sc1
    s_add_u32 s19, s19, 4096
    buffer_load_dwordx4 v[160:163], v7, s[12:15], s19 offen offset:0 sc1
    s_waitcnt vmcnt(4) lgkmcnt(6)
    v_mfma_f32_32x32x16_bf16 v[60:75], v[108:111], v[144:147], 0
    ds_read_b64_tr_b16 v[132:133], v43 offset:14336
    ds_read_b64_tr_b16 v[134:135], v43 offset:15872
    buffer_load_dwordx4 v[164:167], v7, s[12:15], s19 offen offset:1024 sc1
    v_mfma_f32_32x32x16_bf16 v[76:91], v[112:115], v[144:147], 0
    ds_read_b64_tr_b16 v[136:137], v43 offset:14400
    ds_read_b64_tr_b16 v[138:139], v43 offset:15936
    buffer_load_dwordx4 v[168:171], v7, s[12:15], s19 offen offset:2048 sc1
    v_mfma_f32_32x32x16_bf16 v[92:107], v[116:119], v[144:147], 0
    ds_read_b64_tr_b16 v[140:141], v43 offset:14464
    ds_read_b64_tr_b16 v[142:143], v43 offset:16000
    s_waitcnt vmcnt(5) lgkmcnt(6)
    v_mfma_f32_32x32x16_bf16 v[60:75], v[120:123], v[148:151], v[60:75]
    ds_read_b64_tr_b16 v[108:109], v43 offset:17408
    ds_read_b64_tr_b16 v[110:111], v43 offset:18944
    buffer_load_dwordx4 v[172:175], v7, s[12:15], s19 offen offset:3072 sc1
    s_add_u32 s19, s19, 4096
    v_mfma_f32_32x32x16_bf16 v[76:91], v[124:127], v[148:151], v[76:91]
    ds_read_b64_tr_b16 v[112:113], v43 offset:17472
    ds_read_b64_tr_b16 v[114:115], v43 offset:19008
    v_mfma_f32_32x32x16_bf16 v[92:107], v[128:131], v[148:151], v[92:107]
    ds_read_b64_tr_b16 v[116:117], v43 offset:17536
    ds_read_b64_tr_b16 v[118:119], v43 offset:19072
    s_waitcnt vmcnt(5) lgkmcnt(6)
    v_mfma_f32_32x32x16_bf16 v[60:75], v[132:135], v[152:155], v[60:75]
    ds_read_b64_tr_b16 v[120:121], v41 offset:49152
    ds_read_b64_tr_b16 v[122:123], v41 offset:50688
    buffer_load_dwordx4 v[176:179], v7, s[12:15], s19 offen offset:0 sc1
    v_mfma_f32_32x32x16_bf16 v[76:91], v[136:139], v[152:155], v[76:91]
    ds_read_b64_tr_b16 v[124:125], v41 offset:49216
    ds_read_b64_tr_b16 v[126:127], v41 offset:50752
    buffer_load_dwordx4 v[208:211], v7, s[12:15], s20 offen offset:0 sc1
    v_mfma_f32_32x32x16_bf16 v[92:107], v[140:143], v[152:155], v[92:107]
    ds_read_b64_tr_b16 v[128:129], v41 offset:49280
    ds_read_b64_tr_b16 v[130:131], v41 offset:50816
    s_waitcnt vmcnt(6) lgkmcnt(6)
    v_mfma_f32_32x32x16_bf16 v[60:75], v[108:111], v[156:159], v[60:75]
    ds_read_b64_tr_b16 v[132:133], v41 offset:52224
    ds_read_b64_tr_b16 v[134:135], v41 offset:53760
    buffer_load_dwordx4 v[180:183], v7, s[12:15], s19 offen offset:1024 sc1
    v_mfma_f32_32x32x16_bf16 v[76:91], v[112:115], v[156:159], v[76:91]
    ds_read_b64_tr_b16 v[136:137], v41 offset:52288
    ds_read_b64_tr_b16 v[138:139], v41 offset:53824
    buffer_load_dwordx4 v[212:215], v7, s[12:15], s20 offen offset:1024 sc1
    v_mfma_f32_32x32x16_bf16 v[92:107], v[116:119], v[156:159], v[92:107]
    ds_read_b64_tr_b16 v[140:141], v41 offset:52352
    ds_read_b64_tr_b16 v[142:143], v41 offset:53888
    s_waitcnt vmcnt(7) lgkmcnt(6)
    v_mfma_f32_32x32x16_bf16 v[60:75], v[120:123], v[160:163], v[60:75]
    ds_read_b64_tr_b16 v[108:109], v41 offset:55296
    ds_read_b64_tr_b16 v[110:111], v41 offset:56832
    buffer_load_dwordx4 v[184:187], v7, s[12:15], s19 offen offset:2048 sc1
    v_mfma_f32_32x32x16_bf16 v[76:91], v[124:127], v[160:163], v[76:91]
    ds_read_b64_tr_b16 v[112:113], v41 offset:55360
    ds_read_b64_tr_b16 v[114:115], v41 offset:56896
    buffer_load_dwordx4 v[216:219], v7, s[12:15], s20 offen offset:2048 sc1
    v_mfma_f32_32x32x16_bf16 v[92:107], v[128:131], v[160:163], v[92:107]
    ds_read_b64_tr_b16 v[116:117], v41 offset:55424
    ds_read_b64_tr_b16 v[118:119], v41 offset:56960
    s_waitcnt vmcnt(8) lgkmcnt(6)
    v_mfma_f32_32x32x16_bf16 v[60:75], v[132:135], v[164:167], v[60:75]
    ds_read_b64_tr_b16 v[120:121], v41 offset:58368
    ds_read_b64_tr_b16 v[122:123], v41 offset:59904
    buffer_load_dwordx4 v[188:191], v7, s[12:15], s19 offen offset:3072 sc1
    s_add_u32 s19, s19, 4096
    v_mfma_f32_32x32x16_bf16 v[76:91], v[136:139], v[164:167], v[76:91]
    ds_read_b64_tr_b16 v[124:125], v41 offset:58432
    ds_read_b64_tr_b16 v[126:127], v41 offset:59968
    buffer_load_dwordx4 v[220:223], v7, s[12:15], s20 offen offset:3072 sc1
    v_mfma_f32_32x32x16_bf16 v[92:107], v[140:143], v[164:167], v[92:107]
    ds_read_b64_tr_b16 v[128:129], v41 offset:58496
    ds_read_b64_tr_b16 v[130:131], v41 offset:60032
    s_waitcnt vmcnt(9) lgkmcnt(6)
    v_mfma_f32_32x32x16_bf16 v[60:75], v[108:111], v[168:171], v[60:75]
    ds_read_b64_tr_b16 v[132:133], v41 offset:61440
    ds_read_b64_tr_b16 v[134:135], v41 offset:62976
    buffer_load_dwordx4 v[192:195], v7, s[12:15], s19 offen offset:0 sc1
    v_mfma_f32_32x32x16_bf16 v[76:91], v[112:115], v[168:171], v[76:91]
    ds_read_b64_tr_b16 v[136:137], v41 offset:61504
    ds_read_b64_tr_b16 v[138:139], v41 offset:63040
    buffer_load_dwordx4 v[196:199], v7, s[12:15], s19 offen offset:1024 sc1
    v_mfma_f32_32x32x16_bf16 v[92:107], v[116:119], v[168:171], v[92:107]
    ds_read_b64_tr_b16 v[140:141], v41 offset:61568
    ds_read_b64_tr_b16 v[142:143], v41 offset:63104
    s_waitcnt vmcnt(10) lgkmcnt(6)
    v_mfma_f32_32x32x16_bf16 v[60:75], v[120:123], v[172:175], v[60:75]
    ds_read_b64_tr_b16 v[108:109], v41 offset:64512
    ds_read_b64_tr_b16 v[110:111], v42 offset:512
    buffer_load_dwordx4 v[200:203], v7, s[12:15], s19 offen offset:2048 sc1
    v_mfma_f32_32x32x16_bf16 v[76:91], v[124:127], v[172:175], v[76:91]
    ds_read_b64_tr_b16 v[112:113], v41 offset:64576
    ds_read_b64_tr_b16 v[114:115], v42 offset:576
    v_mfma_f32_32x32x16_bf16 v[92:107], v[128:131], v[172:175], v[92:107]
    ds_read_b64_tr_b16 v[116:117], v41 offset:64640
    ds_read_b64_tr_b16 v[118:119], v42 offset:640
    s_waitcnt vmcnt(10) lgkmcnt(6)
    v_mfma_f32_32x32x16_bf16 v[60:75], v[132:135], v[176:179], v[60:75]
    ds_read_b64_tr_b16 v[120:121], v42 offset:2048
    ds_read_b64_tr_b16 v[122:123], v42 offset:3584
    buffer_load_dwordx4 v[204:207], v7, s[12:15], s19 offen offset:3072 sc1
    s_add_u32 s19, s19, 4096
    v_mfma_f32_32x32x16_bf16 v[76:91], v[136:139], v[176:179], v[76:91]
    ds_read_b64_tr_b16 v[124:125], v42 offset:2112
    ds_read_b64_tr_b16 v[126:127], v42 offset:3648
    v_mfma_f32_32x32x16_bf16 v[92:107], v[140:143], v[176:179], v[92:107]
    ds_read_b64_tr_b16 v[128:129], v42 offset:2176
    ds_read_b64_tr_b16 v[130:131], v42 offset:3712
    s_waitcnt vmcnt(9) lgkmcnt(6)
    v_mfma_f32_32x32x16_bf16 v[60:75], v[108:111], v[180:183], v[60:75]
    ds_read_b64_tr_b16 v[132:133], v42 offset:5120
    ds_read_b64_tr_b16 v[134:135], v42 offset:6656
    buffer_load_dwordx4 v[144:147], v7, s[12:15], s19 offen offset:0 sc1
    v_mfma_f32_32x32x16_bf16 v[76:91], v[112:115], v[180:183], v[76:91]
    ds_read_b64_tr_b16 v[136:137], v42 offset:5184
    ds_read_b64_tr_b16 v[138:139], v42 offset:6720
    v_mfma_f32_32x32x16_bf16 v[92:107], v[116:119], v[180:183], v[92:107]
    ds_read_b64_tr_b16 v[140:141], v42 offset:5248
    ds_read_b64_tr_b16 v[142:143], v42 offset:6784
    s_waitcnt vmcnt(8) lgkmcnt(6)
    v_mfma_f32_32x32x16_bf16 v[60:75], v[120:123], v[184:187], v[60:75]
    ds_read_b64_tr_b16 v[108:109], v42 offset:8192
    ds_read_b64_tr_b16 v[110:111], v42 offset:9728
    buffer_load_dwordx4 v[148:151], v7, s[12:15], s19 offen offset:1024 sc1
    v_mfma_f32_32x32x16_bf16 v[76:91], v[124:127], v[184:187], v[76:91]
    ds_read_b64_tr_b16 v[112:113], v42 offset:8256
    ds_read_b64_tr_b16 v[114:115], v42 offset:9792
    v_mfma_f32_32x32x16_bf16 v[92:107], v[128:131], v[184:187], v[92:107]
    ds_read_b64_tr_b16 v[116:117], v42 offset:8320
    ds_read_b64_tr_b16 v[118:119], v42 offset:9856
    s_waitcnt vmcnt(7) lgkmcnt(6)
    v_mfma_f32_32x32x16_bf16 v[60:75], v[132:135], v[188:191], v[60:75]
    ds_read_b64_tr_b16 v[120:121], v42 offset:11264
    ds_read_b64_tr_b16 v[122:123], v42 offset:12800
    buffer_load_dwordx4 v[152:155], v7, s[12:15], s19 offen offset:2048 sc1
    v_mfma_f32_32x32x16_bf16 v[76:91], v[136:139], v[188:191], v[76:91]
    ds_read_b64_tr_b16 v[124:125], v42 offset:11328
    ds_read_b64_tr_b16 v[126:127], v42 offset:12864
    v_mfma_f32_32x32x16_bf16 v[92:107], v[140:143], v[188:191], v[92:107]
    ds_read_b64_tr_b16 v[128:129], v42 offset:11392
    ds_read_b64_tr_b16 v[130:131], v42 offset:12928
    s_waitcnt vmcnt(6) lgkmcnt(6)
    v_mfma_f32_32x32x16_bf16 v[60:75], v[108:111], v[192:195], v[60:75]
    ds_read_b64_tr_b16 v[132:133], v42 offset:14336
    ds_read_b64_tr_b16 v[134:135], v42 offset:15872
    buffer_load_dwordx4 v[156:159], v7, s[12:15], s19 offen offset:3072 sc1
    s_add_u32 s19, s19, 4096
    v_mfma_f32_32x32x16_bf16 v[76:91], v[112:115], v[192:195], v[76:91]
    ds_read_b64_tr_b16 v[136:137], v42 offset:14400
    ds_read_b64_tr_b16 v[138:139], v42 offset:15936
    v_mfma_f32_32x32x16_bf16 v[92:107], v[116:119], v[192:195], v[92:107]
    ds_read_b64_tr_b16 v[140:141], v42 offset:14464
    ds_read_b64_tr_b16 v[142:143], v42 offset:16000
    s_waitcnt vmcnt(6) lgkmcnt(6)
    v_mfma_f32_32x32x16_bf16 v[60:75], v[120:123], v[196:199], v[60:75]
    ds_read_b64_tr_b16 v[108:109], v42 offset:17408
    ds_read_b64_tr_b16 v[110:111], v42 offset:18944
    buffer_load_dwordx4 v[160:163], v7, s[12:15], s19 offen offset:0 sc1
    v_mfma_f32_32x32x16_bf16 v[76:91], v[124:127], v[196:199], v[76:91]
    ds_read_b64_tr_b16 v[112:113], v42 offset:17472
    ds_read_b64_tr_b16 v[114:115], v42 offset:19008
    v_mfma_f32_32x32x16_bf16 v[92:107], v[128:131], v[196:199], v[92:107]
    ds_read_b64_tr_b16 v[116:117], v42 offset:17536
    ds_read_b64_tr_b16 v[118:119], v42 offset:19072
    s_waitcnt vmcnt(6) lgkmcnt(6)
    v_mfma_f32_32x32x16_bf16 v[60:75], v[132:135], v[200:203], v[60:75]
    ds_read_b64_tr_b16 v[120:121], v42 offset:20480
    ds_read_b64_tr_b16 v[122:123], v42 offset:22016
    buffer_load_dwordx4 v[164:167], v7, s[12:15], s19 offen offset:1024 sc1
    v_add_f32 v208, v208, v216
    v_add_f32 v209, v209, v217
    v_mfma_f32_32x32x16_bf16 v[76:91], v[136:139], v[200:203], v[76:91]
    ds_read_b64_tr_b16 v[124:125], v42 offset:20544
    ds_read_b64_tr_b16 v[126:127], v42 offset:22080
    v_add_f32 v210, v210, v218
    v_add_f32 v211, v211, v219
    v_mfma_f32_32x32x16_bf16 v[92:107], v[140:143], v[200:203], v[92:107]
    ds_read_b64_tr_b16 v[128:129], v42 offset:20608
    ds_read_b64_tr_b16 v[130:131], v42 offset:22144
    v_add_f32 v212, v212, v220
    v_add_f32 v213, v213, v221
    s_waitcnt vmcnt(6) lgkmcnt(6)
    v_mfma_f32_32x32x16_bf16 v[60:75], v[108:111], v[204:207], v[60:75]
    ds_read_b64_tr_b16 v[132:133], v42 offset:23552
    ds_read_b64_tr_b16 v[134:135], v42 offset:25088
    buffer_load_dwordx4 v[168:171], v7, s[12:15], s19 offen offset:2048 sc1
    v_add_f32 v214, v214, v222
    v_add_f32 v215, v215, v223
    v_mfma_f32_32x32x16_bf16 v[76:91], v[112:115], v[204:207], v[76:91]
    ds_read_b64_tr_b16 v[136:137], v42 offset:23616
    ds_read_b64_tr_b16 v[138:139], v42 offset:25152
    v_add_f32 v208, v208, v212
    v_add_f32 v209, v209, v213
    v_mfma_f32_32x32x16_bf16 v[92:107], v[116:119], v[204:207], v[92:107]
    ds_read_b64_tr_b16 v[140:141], v42 offset:23680
    ds_read_b64_tr_b16 v[142:143], v42 offset:25216
    v_add_f32 v210, v210, v214
    v_add_f32 v211, v211, v215
    s_waitcnt vmcnt(6) lgkmcnt(6)
    v_mfma_f32_32x32x16_bf16 v[60:75], v[120:123], v[144:147], v[60:75]
    ds_read_b64_tr_b16 v[108:109], v42 offset:26624
    ds_read_b64_tr_b16 v[110:111], v42 offset:28160
    buffer_load_dwordx4 v[172:175], v7, s[12:15], s19 offen offset:3072 sc1
    s_add_u32 s19, s19, 4096
    v_add_f32 v208, v208, v210
    v_add_f32 v209, v209, v211
    v_mfma_f32_32x32x16_bf16 v[76:91], v[124:127], v[144:147], v[76:91]
    ds_read_b64_tr_b16 v[112:113], v42 offset:26688
    ds_read_b64_tr_b16 v[114:115], v42 offset:28224
    v_mov_b32 v4, v208
    v_mov_b32 v5, v209
    v_mfma_f32_32x32x16_bf16 v[92:107], v[128:131], v[144:147], v[92:107]
    ds_read_b64_tr_b16 v[116:117], v42 offset:26752
    ds_read_b64_tr_b16 v[118:119], v42 offset:28288
    s_nop 1
    v_permlane32_swap_b32 v4, v208
    s_waitcnt vmcnt(6) lgkmcnt(6)
    v_mfma_f32_32x32x16_bf16 v[60:75], v[132:135], v[148:151], v[60:75]
    ds_read_b64_tr_b16 v[120:121], v42 offset:29696
    ds_read_b64_tr_b16 v[122:123], v42 offset:31232
    buffer_load_dwordx4 v[176:179], v7, s[12:15], s19 offen offset:0 sc1
    v_permlane32_swap_b32 v5, v209
    s_nop 1
    v_mfma_f32_32x32x16_bf16 v[76:91], v[136:139], v[148:151], v[76:91]
    ds_read_b64_tr_b16 v[124:125], v42 offset:29760
    ds_read_b64_tr_b16 v[126:127], v42 offset:31296
    v_add_f32 v4, v4, v208
    v_add_f32 v5, v5, v209
    v_mfma_f32_32x32x16_bf16 v[92:107], v[140:143], v[148:151], v[92:107]
    ds_read_b64_tr_b16 v[128:129], v42 offset:29824
    ds_read_b64_tr_b16 v[130:131], v42 offset:31360
    v_mul_f32 v50, 0xbb000000, v4
    v_mul_f32 v5, 0x3b000000, v5
    s_waitcnt vmcnt(6) lgkmcnt(6)
    v_mfma_f32_32x32x16_bf16 v[60:75], v[108:111], v[152:155], v[60:75]
    ds_read_b64_tr_b16 v[132:133], v42 offset:32768
    ds_read_b64_tr_b16 v[134:135], v42 offset:34304
    buffer_load_dwordx4 v[180:183], v7, s[12:15], s19 offen offset:1024 sc1
    v_fma_f32 v5, -v50, v50, v5
    v_max_f32 v5, 0, v5
    v_mfma_f32_32x32x16_bf16 v[76:91], v[112:115], v[152:155], v[76:91]
    ds_read_b64_tr_b16 v[136:137], v42 offset:32832
    ds_read_b64_tr_b16 v[138:139], v42 offset:34368
    v_add_f32 v5, 0x3727c5ac, v5
    v_rsq_f32 v52, v5
    v_mfma_f32_32x32x16_bf16 v[92:107], v[116:119], v[152:155], v[92:107]
    ds_read_b64_tr_b16 v[140:141], v42 offset:32896
    ds_read_b64_tr_b16 v[142:143], v42 offset:34432
    s_nop 0
    s_waitcnt vmcnt(6) lgkmcnt(6)
    v_mfma_f32_32x32x16_bf16 v[60:75], v[120:123], v[156:159], v[60:75]
    ds_read_b64_tr_b16 v[108:109], v42 offset:35840
    ds_read_b64_tr_b16 v[110:111], v42 offset:37376
    buffer_load_dwordx4 v[184:187], v7, s[12:15], s19 offen offset:2048 sc1
    v_mfma_f32_32x32x16_bf16 v[76:91], v[124:127], v[156:159], v[76:91]
    ds_read_b64_tr_b16 v[112:113], v42 offset:35904
    ds_read_b64_tr_b16 v[114:115], v42 offset:37440
    v_mfma_f32_32x32x16_bf16 v[92:107], v[128:131], v[156:159], v[92:107]
    ds_read_b64_tr_b16 v[116:117], v42 offset:35968
    ds_read_b64_tr_b16 v[118:119], v42 offset:37504
    s_waitcnt vmcnt(6) lgkmcnt(6)
    v_mfma_f32_32x32x16_bf16 v[60:75], v[132:135], v[160:163], v[60:75]
    ds_read_b64_tr_b16 v[120:121], v42 offset:38912
    ds_read_b64_tr_b16 v[122:123], v42 offset:40448
    buffer_load_dwordx4 v[188:191], v7, s[12:15], s19 offen offset:3072 sc1
    s_add_u32 s19, s19, 4096
    v_mfma_f32_32x32x16_bf16 v[76:91], v[136:139], v[160:163], v[76:91]
    ds_read_b64_tr_b16 v[124:125], v42 offset:38976
    ds_read_b64_tr_b16 v[126:127], v42 offset:40512
    v_mfma_f32_32x32x16_bf16 v[92:107], v[140:143], v[160:163], v[92:107]
    ds_read_b64_tr_b16 v[128:129], v42 offset:39040
    ds_read_b64_tr_b16 v[130:131], v42 offset:40576
    s_waitcnt vmcnt(6) lgkmcnt(6)
    v_mfma_f32_32x32x16_bf16 v[60:75], v[108:111], v[164:167], v[60:75]
    ds_read_b64_tr_b16 v[132:133], v42 offset:41984
    ds_read_b64_tr_b16 v[134:135], v42 offset:43520
    buffer_load_dwordx4 v[192:195], v7, s[12:15], s19 offen offset:0 sc1
    v_mfma_f32_32x32x16_bf16 v[76:91], v[112:115], v[164:167], v[76:91]
    ds_read_b64_tr_b16 v[136:137], v42 offset:42048
    ds_read_b64_tr_b16 v[138:139], v42 offset:43584
    v_mfma_f32_32x32x16_bf16 v[92:107], v[116:119], v[164:167], v[92:107]
    ds_read_b64_tr_b16 v[140:141], v42 offset:42112
    ds_read_b64_tr_b16 v[142:143], v42 offset:43648
    s_barrier
    s_waitcnt vmcnt(6) lgkmcnt(6)
    v_mfma_f32_32x32x16_bf16 v[60:75], v[120:123], v[168:171], v[60:75]
    ds_read_b64_tr_b16 v[108:109], v42 offset:45056
    ds_read_b64_tr_b16 v[110:111], v42 offset:46592
    buffer_load_dwordx4 v[196:199], v7, s[12:15], s19 offen offset:1024 sc1
    v_mfma_f32_32x32x16_bf16 v[76:91], v[124:127], v[168:171], v[76:91]
    ds_read_b64_tr_b16 v[112:113], v42 offset:45120
    ds_read_b64_tr_b16 v[114:115], v42 offset:46656
    v_mfma_f32_32x32x16_bf16 v[92:107], v[128:131], v[168:171], v[92:107]
    ds_read_b64_tr_b16 v[116:117], v42 offset:45184
    ds_read_b64_tr_b16 v[118:119], v42 offset:46720
    s_waitcnt vmcnt(6) lgkmcnt(6)
    v_mfma_f32_32x32x16_bf16 v[60:75], v[132:135], v[172:175], v[60:75]
    ds_read_b64_tr_b16 v[120:121], v42 offset:48128
    ds_read_b64_tr_b16 v[122:123], v42 offset:49664
    buffer_load_dwordx4 v[200:203], v7, s[12:15], s19 offen offset:2048 sc1
    v_mfma_f32_32x32x16_bf16 v[76:91], v[136:139], v[172:175], v[76:91]
    ds_read_b64_tr_b16 v[124:125], v42 offset:48192
    ds_read_b64_tr_b16 v[126:127], v42 offset:49728
    v_mfma_f32_32x32x16_bf16 v[92:107], v[140:143], v[172:175], v[92:107]
    ds_read_b64_tr_b16 v[128:129], v42 offset:48256
    ds_read_b64_tr_b16 v[130:131], v42 offset:49792
    s_waitcnt vmcnt(6) lgkmcnt(6)
    v_mfma_f32_32x32x16_bf16 v[60:75], v[108:111], v[176:179], v[60:75]
    ds_read_b64_tr_b16 v[132:133], v42 offset:51200
    ds_read_b64_tr_b16 v[134:135], v42 offset:52736
    buffer_load_dwordx4 v[204:207], v7, s[12:15], s19 offen offset:3072 sc1
    s_add_u32 s19, s19, 4096
    v_mfma_f32_32x32x16_bf16 v[76:91], v[112:115], v[176:179], v[76:91]
    ds_read_b64_tr_b16 v[136:137], v42 offset:51264
    ds_read_b64_tr_b16 v[138:139], v42 offset:52800
    v_mfma_f32_32x32x16_bf16 v[92:107], v[116:119], v[176:179], v[92:107]
    ds_read_b64_tr_b16 v[140:141], v42 offset:51328
    ds_read_b64_tr_b16 v[142:143], v42 offset:52864
    s_waitcnt vmcnt(6) lgkmcnt(6)
    v_mfma_f32_32x32x16_bf16 v[60:75], v[120:123], v[180:183], v[60:75]
    ds_read_b64_tr_b16 v[108:109], v42 offset:54272
    ds_read_b64_tr_b16 v[110:111], v42 offset:55808
    v_mfma_f32_32x32x16_bf16 v[76:91], v[124:127], v[180:183], v[76:91]
    ds_read_b64_tr_b16 v[112:113], v42 offset:54336
    ds_read_b64_tr_b16 v[114:115], v42 offset:55872
    v_mfma_f32_32x32x16_bf16 v[92:107], v[128:131], v[180:183], v[92:107]
    ds_read_b64_tr_b16 v[116:117], v42 offset:54400
    ds_read_b64_tr_b16 v[118:119], v42 offset:55936
    s_waitcnt vmcnt(5) lgkmcnt(6)
    v_mfma_f32_32x32x16_bf16 v[60:75], v[132:135], v[184:187], v[60:75]
    ds_read_b64_tr_b16 v[120:121], v42 offset:57344
    ds_read_b64_tr_b16 v[122:123], v42 offset:58880
    v_mfma_f32_32x32x16_bf16 v[76:91], v[136:139], v[184:187], v[76:91]
    ds_read_b64_tr_b16 v[124:125], v42 offset:57408
    ds_read_b64_tr_b16 v[126:127], v42 offset:58944
    v_mfma_f32_32x32x16_bf16 v[92:107], v[140:143], v[184:187], v[92:107]
    ds_read_b64_tr_b16 v[128:129], v42 offset:57472
    ds_read_b64_tr_b16 v[130:131], v42 offset:59008
    s_waitcnt vmcnt(4) lgkmcnt(6)
    v_mfma_f32_32x32x16_bf16 v[60:75], v[108:111], v[188:191], v[60:75]
    ds_read_b64_tr_b16 v[132:133], v42 offset:60416
    ds_read_b64_tr_b16 v[134:135], v42 offset:61952
    v_mfma_f32_32x32x16_bf16 v[76:91], v[112:115], v[188:191], v[76:91]
    ds_read_b64_tr_b16 v[136:137], v42 offset:60480
    ds_read_b64_tr_b16 v[138:139], v42 offset:62016
    v_mfma_f32_32x32x16_bf16 v[92:107], v[116:119], v[188:191], v[92:107]
    ds_read_b64_tr_b16 v[140:141], v42 offset:60544
    ds_read_b64_tr_b16 v[142:143], v42 offset:62080
    s_waitcnt vmcnt(3) lgkmcnt(6)
    v_mfma_f32_32x32x16_bf16 v[60:75], v[120:123], v[192:195], v[60:75]
    ds_read_b64_tr_b16 v[108:109], v42 offset:63488
    ds_read_b64_tr_b16 v[110:111], v42 offset:65024
    v_mfma_f32_32x32x16_bf16 v[76:91], v[124:127], v[192:195], v[76:91]
    ds_read_b64_tr_b16 v[112:113], v42 offset:63552
    ds_read_b64_tr_b16 v[114:115], v42 offset:65088
    v_mfma_f32_32x32x16_bf16 v[92:107], v[128:131], v[192:195], v[92:107]
    ds_read_b64_tr_b16 v[116:117], v42 offset:63616
    ds_read_b64_tr_b16 v[118:119], v42 offset:65152
    s_waitcnt vmcnt(2) lgkmcnt(6)
    v_mfma_f32_32x32x16_bf16 v[60:75], v[132:135], v[196:199], v[60:75]
    ds_read_b64_tr_b16 v[120:121], v43 offset:1024
    ds_read_b64_tr_b16 v[122:123], v43 offset:2560
    v_mfma_f32_32x32x16_bf16 v[76:91], v[136:139], v[196:199], v[76:91]
    ds_read_b64_tr_b16 v[124:125], v43 offset:1088
    ds_read_b64_tr_b16 v[126:127], v43 offset:2624
    v_mfma_f32_32x32x16_bf16 v[92:107], v[140:143], v[196:199], v[92:107]
    ds_read_b64_tr_b16 v[128:129], v43 offset:1152
    ds_read_b64_tr_b16 v[130:131], v43 offset:2688
    s_waitcnt vmcnt(1) lgkmcnt(6)
    v_mfma_f32_32x32x16_bf16 v[60:75], v[108:111], v[200:203], v[60:75]
    ds_read_b128 v[144:147], v37 offset:1024
    ds_read_b128 v[148:151], v37 offset:1056
    v_mfma_f32_32x32x16_bf16 v[76:91], v[112:115], v[200:203], v[76:91]
    ds_read_b128 v[152:155], v37 offset:1088
    ds_read_b128 v[156:159], v37 offset:1120
    v_mfma_f32_32x32x16_bf16 v[92:107], v[116:119], v[200:203], v[92:107]
    ds_read_b128 v[160:163], v37 offset:1152
    ds_read_b128 v[164:167], v37 offset:1184
    s_waitcnt vmcnt(0) lgkmcnt(6)
    v_mfma_f32_32x32x16_bf16 v[60:75], v[120:123], v[204:207], v[60:75]
    ds_read_b128 v[168:171], v37 offset:1216
    ds_read_b128 v[172:175], v37 offset:1248
    v_mfma_f32_32x32x16_bf16 v[76:91], v[124:127], v[204:207], v[76:91]
    ds_read_b128 v[176:179], v37 offset:1280
    ds_read_b128 v[180:183], v37 offset:1312
    v_mfma_f32_32x32x16_bf16 v[92:107], v[128:131], v[204:207], v[92:107]
    ds_read_b128 v[184:187], v37 offset:1344
    ds_read_b128 v[188:191], v37 offset:1376
    s_mul_i32 s6, s17, 3
    s_lshl_b32 s7, s57, 10
    s_add_u32 s7, s7, 0x1200000
    s_add_u32 s5, s6, 0
    s_lshl_b32 s20, s5, 17
    s_add_u32 s20, s20, s7
    s_add_u32 s21, s20, 65536
    s_cmp_lt_u32 s5, 16
    s_cselect_b32 s32, 0x3eb8aa3b, 1.0
    s_cmp_lt_u32 s5, 32
    s_cselect_b64 vcc, -1, 0
    v_mul_f32 v54, s32, v52
    v_cndmask_b32 v38, v39, v7, vcc
    s_waitcnt lgkmcnt(8)
.p2align 3
    v_pk_fma_f32 v[60:61], v[144:145], v[50:51], v[60:61] op_sel_hi:[1,0,1]
    v_pk_fma_f32 v[62:63], v[146:147], v[50:51], v[62:63] op_sel_hi:[1,0,1]
    v_pk_fma_f32 v[64:65], v[148:149], v[50:51], v[64:65] op_sel_hi:[1,0,1]
    v_pk_fma_f32 v[66:67], v[150:151], v[50:51], v[66:67] op_sel_hi:[1,0,1]
    v_pk_fma_f32 v[68:69], v[152:153], v[50:51], v[68:69] op_sel_hi:[1,0,1]
    v_pk_fma_f32 v[70:71], v[154:155], v[50:51], v[70:71] op_sel_hi:[1,0,1]
    v_pk_fma_f32 v[72:73], v[156:157], v[50:51], v[72:73] op_sel_hi:[1,0,1]
    v_pk_fma_f32 v[74:75], v[158:159], v[50:51], v[74:75] op_sel_hi:[1,0,1]
    v_pk_mul_f32 v[60:61], v[60:61], v[54:55] op_sel_hi:[1,0]
    v_pk_mul_f32 v[62:63], v[62:63], v[54:55] op_sel_hi:[1,0]
    v_pk_mul_f32 v[64:65], v[64:65], v[54:55] op_sel_hi:[1,0]
    v_pk_mul_f32 v[66:67], v[66:67], v[54:55] op_sel_hi:[1,0]
    v_pk_mul_f32 v[68:69], v[68:69], v[54:55] op_sel_hi:[1,0]
    v_pk_mul_f32 v[70:71], v[70:71], v[54:55] op_sel_hi:[1,0]
    v_pk_mul_f32 v[72:73], v[72:73], v[54:55] op_sel_hi:[1,0]
    v_pk_mul_f32 v[74:75], v[74:75], v[54:55] op_sel_hi:[1,0]
    v_cvt_pk_bf16_f32 v208, v60, v61
    v_cvt_pk_bf16_f32 v209, v62, v63
    v_cvt_pk_bf16_f32 v210, v64, v65
    v_cvt_pk_bf16_f32 v211, v66, v67
    v_cvt_pk_bf16_f32 v212, v68, v69
    v_cvt_pk_bf16_f32 v213, v70, v71
    v_cvt_pk_bf16_f32 v214, v72, v73
    v_cvt_pk_bf16_f32 v215, v74, v75
    buffer_store_dwordx4 v[208:211], v38, s[12:15], s20 offen sc1
    buffer_store_dwordx4 v[212:215], v38, s[12:15], s21 offen sc1
    s_add_u32 s5, s6, 1
    s_lshl_b32 s20, s5, 17
    s_add_u32 s20, s20, s7
    s_add_u32 s21, s20, 65536
    s_cmp_lt_u32 s5, 16
    s_cselect_b32 s32, 0x3eb8aa3b, 1.0
    s_cmp_lt_u32 s5, 32
    s_cselect_b64 vcc, -1, 0
    v_mul_f32 v54, s32, v52
    v_cndmask_b32 v38, v39, v7, vcc
    s_waitcnt lgkmcnt(4)
.p2align 3
    v_pk_fma_f32 v[76:77], v[160:161], v[50:51], v[76:77] op_sel_hi:[1,0,1]
    v_pk_fma_f32 v[78:79], v[162:163], v[50:51], v[78:79] op_sel_hi:[1,0,1]
    v_pk_fma_f32 v[80:81], v[164:165], v[50:51], v[80:81] op_sel_hi:[1,0,1]
    v_pk_fma_f32 v[82:83], v[166:167], v[50:51], v[82:83] op_sel_hi:[1,0,1]
    v_pk_fma_f32 v[84:85], v[168:169], v[50:51], v[84:85] op_sel_hi:[1,0,1]
    v_pk_fma_f32 v[86:87], v[170:171], v[50:51], v[86:87] op_sel_hi:[1,0,1]
    v_pk_fma_f32 v[88:89], v[172:173], v[50:51], v[88:89] op_sel_hi:[1,0,1]
    v_pk_fma_f32 v[90:91], v[174:175], v[50:51], v[90:91] op_sel_hi:[1,0,1]
    v_pk_mul_f32 v[76:77], v[76:77], v[54:55] op_sel_hi:[1,0]
    v_pk_mul_f32 v[78:79], v[78:79], v[54:55] op_sel_hi:[1,0]
    v_pk_mul_f32 v[80:81], v[80:81], v[54:55] op_sel_hi:[1,0]
    v_pk_mul_f32 v[82:83], v[82:83], v[54:55] op_sel_hi:[1,0]
    v_pk_mul_f32 v[84:85], v[84:85], v[54:55] op_sel_hi:[1,0]
    v_pk_mul_f32 v[86:87], v[86:87], v[54:55] op_sel_hi:[1,0]
    v_pk_mul_f32 v[88:89], v[88:89], v[54:55] op_sel_hi:[1,0]
    v_pk_mul_f32 v[90:91], v[90:91], v[54:55] op_sel_hi:[1,0]
    v_cvt_pk_bf16_f32 v216, v76, v77
    v_cvt_pk_bf16_f32 v217, v78, v79
    v_cvt_pk_bf16_f32 v218, v80, v81
    v_cvt_pk_bf16_f32 v219, v82, v83
    v_cvt_pk_bf16_f32 v220, v84, v85
    v_cvt_pk_bf16_f32 v221, v86, v87
    v_cvt_pk_bf16_f32 v222, v88, v89
    v_cvt_pk_bf16_f32 v223, v90, v91
    buffer_store_dwordx4 v[216:219], v38, s[12:15], s20 offen sc1
    buffer_store_dwordx4 v[220:223], v38, s[12:15], s21 offen sc1
    s_add_u32 s5, s6, 2
    s_lshl_b32 s20, s5, 17
    s_add_u32 s20, s20, s7
    s_add_u32 s21, s20, 65536
    s_cmp_lt_u32 s5, 16
    s_cselect_b32 s32, 0x3eb8aa3b, 1.0
    s_cmp_lt_u32 s5, 32
    s_cselect_b64 vcc, -1, 0
    v_mul_f32 v54, s32, v52
    v_cndmask_b32 v38, v39, v7, vcc
    s_waitcnt lgkmcnt(0)
.p2align 3
    v_pk_fma_f32 v[92:93], v[176:177], v[50:51], v[92:93] op_sel_hi:[1,0,1]
    v_pk_fma_f32 v[94:95], v[178:179], v[50:51], v[94:95] op_sel_hi:[1,0,1]
    v_pk_fma_f32 v[96:97], v[180:181], v[50:51], v[96:97] op_sel_hi:[1,0,1]
    v_pk_fma_f32 v[98:99], v[182:183], v[50:51], v[98:99] op_sel_hi:[1,0,1]
    v_pk_fma_f32 v[100:101], v[184:185], v[50:51], v[100:101] op_sel_hi:[1,0,1]
    v_pk_fma_f32 v[102:103], v[186:187], v[50:51], v[102:103] op_sel_hi:[1,0,1]
    v_pk_fma_f32 v[104:105], v[188:189], v[50:51], v[104:105] op_sel_hi:[1,0,1]
    v_pk_fma_f32 v[106:107], v[190:191], v[50:51], v[106:107] op_sel_hi:[1,0,1]
    v_pk_mul_f32 v[92:93], v[92:93], v[54:55] op_sel_hi:[1,0]
    v_pk_mul_f32 v[94:95], v[94:95], v[54:55] op_sel_hi:[1,0]
    v_pk_mul_f32 v[96:97], v[96:97], v[54:55] op_sel_hi:[1,0]
    v_pk_mul_f32 v[98:99], v[98:99], v[54:55] op_sel_hi:[1,0]
    v_pk_mul_f32 v[100:101], v[100:101], v[54:55] op_sel_hi:[1,0]
    v_pk_mul_f32 v[102:103], v[102:103], v[54:55] op_sel_hi:[1,0]
    v_pk_mul_f32 v[104:105], v[104:105], v[54:55] op_sel_hi:[1,0]
    v_pk_mul_f32 v[106:107], v[106:107], v[54:55] op_sel_hi:[1,0]
    v_cvt_pk_bf16_f32 v224, v92, v93
    v_cvt_pk_bf16_f32 v225, v94, v95
    v_cvt_pk_bf16_f32 v226, v96, v97
    v_cvt_pk_bf16_f32 v227, v98, v99
    v_cvt_pk_bf16_f32 v228, v100, v101
    v_cvt_pk_bf16_f32 v229, v102, v103
    v_cvt_pk_bf16_f32 v230, v104, v105
    v_cvt_pk_bf16_f32 v231, v106, v107
    buffer_store_dwordx4 v[224:227], v38, s[12:15], s20 offen sc1
    buffer_store_dwordx4 v[228:231], v38, s[12:15], s21 offen sc1
    s_lshl_b32 s59, s57, 4
    s_add_u32 s59, s59, s17
    s_lshl_b32 s59, s59, 7
    s_add_u32 s59, s59, 0x1920000
ac_second:
    s_mov_b32 s101, 1
    s_branch ac_body
ac_end:
    s_endpgm
ac_f1last:
    s_cmp_eq_u32 s34, 1
    s_cbranch_scc0 st_41
    buffer_store_dwordx4 v[144:147], v7, s[12:15], s21 offen offset:0 nt
    buffer_store_dwordx4 v[148:151], v7, s[12:15], s21 offen offset:1024 nt
st_42:
    s_branch ac_f1done
ac_f1idle:
    s_barrier
    s_barrier
    s_branch ac_f1done
ac_final:
    s_lshl_b32 s5, s23, 2
    v_add_u32 v4, s5, v3
    v_and_b32 v5, 7, v0
    v_permlane32_swap_b32 v24, v26
    v_permlane32_swap_b32 v25, v27
    v_permlane32_swap_b32 v28, v30
    v_permlane32_swap_b32 v29, v31
    v_xor_b32 v4, v4, v5
    v_lshlrev_b32 v4, 4, v4
    v_lshl_add_u32 v4, v2, 7, v4
    s_lshl_b32 s5, s22, 12
    s_add_u32 s5, s5, 49152
    v_add_u32 v4, s5, v4
    v_xor_b32 v6, 32, v4
    ds_write_b128 v4, v[24:27]
    ds_write_b128 v6, v[28:31]
    v_lshrrev_b32 v4, 3, v1
    v_xor_b32 v6, v4, v5
    v_lshlrev_b32 v6, 4, v6
    v_lshl_add_u32 v6, v4, 7, v6
    s_lshl_b32 s6, s23, 11
    s_add_u32 s5, s5, s6
    v_add_u32 v6, s5, v6
    v_lshlrev_b32 v5, 4, v5
    v_lshl_add_u32 v5, v4, 10, v5
    s_lshl_b32 s28, s24, 15
    s_lshl_b32 s5, s23, 14
    s_add_u32 s28, s28, s5
    s_lshl_b32 s5, s25, 7
    s_add_u32 s28, s28, s5
    s_add_u32 s29, s28, 8192
    s_waitcnt lgkmcnt(0)
    s_barrier
    ds_read_b128 v[60:63], v6
    ds_read_b128 v[64:67], v6 offset:1024
    s_waitcnt lgkmcnt(1)
    buffer_store_dwordx4 v[60:63], v5, s[36:39], s28 offen nt
    s_waitcnt lgkmcnt(0)
    buffer_store_dwordx4 v[64:67], v5, s[36:39], s29 offen nt
    s_endpgm
st_15:
    buffer_store_dwordx4 v[24:27], v7, s[12:15], s26 offen sc1
    buffer_store_dwordx4 v[28:31], v7, s[12:15], s26 offen offset:1024 sc1
    s_branch st_16
st_17:
    buffer_store_dword v56, v36, s[12:15], s27 offen sc1
    s_branch st_18
st_19:
    buffer_store_dword v11, off, s[12:15], s59 offset:0 sc1
    s_branch st_20
st_23:
    buffer_store_dwordx4 v[144:147], v7, s[12:15], s21 offen offset:0 sc1
    buffer_store_dwordx4 v[148:151], v7, s[12:15], s21 offen offset:1024 sc1
    s_branch st_24
st_25:
    buffer_store_dwordx4 v[160:163], v7, s[12:15], s21 offen offset:2048 sc1
    buffer_store_dwordx4 v[164:167], v7, s[12:15], s21 offen offset:3072 sc1
    s_branch st_26
st_27:
    buffer_store_dwordx4 v[176:179], v7, s[12:15], s20 offen offset:0 sc1
    buffer_store_dwordx4 v[180:183], v7, s[12:15], s20 offen offset:1024 sc1
    s_branch st_28
st_29:
    buffer_store_dword v11, off, s[12:15], s59 offset:256 sc1
    s_branch st_30
st_33:
    buffer_store_dwordx4 v[24:27], v7, s[12:15], s26 offen sc1
    buffer_store_dwordx4 v[28:31], v7, s[12:15], s26 offen offset:1024 sc1
    s_branch st_34
st_35:
    buffer_store_dword v56, v36, s[12:15], s27 offen sc1
    s_branch st_36
st_37:
    buffer_store_dword v11, off, s[12:15], s59 offset:512 sc1
    s_branch st_38
st_41:
    buffer_store_dwordx4 v[144:147], v7, s[12:15], s21 offen offset:0 sc1
    buffer_store_dwordx4 v[148:151], v7, s[12:15], s21 offen offset:1024 sc1
    s_branch st_42
ac_loader:
    s_and_b32 s19, s18, 3
    s_lshl_b32 s5, s22, 15
    s_lshl_b32 s6, s25, 7
    s_add_u32 s5, s5, s6
    s_mul_i32 s20, s23, 704512
    s_add_u32 s20, s20, s5
    s_mov_b32 s30, s20
    s_lshl_b32 s24, s19, 12
    s_mul_i32 s26, s19, 3072
    s_mul_i32 s5, s17, 192
    s_mul_i32 s27, s19, 44032
    s_add_u32 s27, s27, s5
    s_add_u32 s27, s27, 880640
    s_mul_i32 s28, s19, 49152
    s_add_u32 s28, s28, s5
    s_lshl_b32 s89, s4, 2
    s_add_u32 s89, s89, s19
    s_mul_i32 s89, s89, 12288
    s_min_u32 s29, s19, 2
    s_lshl_b32 s5, s29, 6
    v_add_u32 v41, s5, v41
    v_add_u32 v42, s5, v42
    v_add_u32 v43, s5, v43
    s_lshl_b32 s5, s29, 7
    v_add_u32 v37, s5, v37
    s_waitcnt vmcnt(0)
    s_mov_b64 exec, 1
    buffer_store_dword v11, off, s[12:15], s21 sc1
    s_mov_b64 exec, -1
    s_barrier
    s_mul_i32 s5, s17, 192
    buffer_load_dword v6, v8, s[60:63], s5 offen
    buffer_load_dwordx4 v[112:115], v13, s[48:51], s20 offen offset:0
    buffer_load_dwordx4 v[116:119], v14, s[48:51], s20 offen offset:1024
    buffer_load_dwordx4 v[120:123], v15, s[48:51], s20 offen offset:2048
    buffer_load_dwordx4 v[124:127], v16, s[48:51], s20 offen offset:3072
    s_add_u32 s20, s20, 65536
    buffer_load_dwordx4 v[128:131], v13, s[48:51], s20 offen offset:0
    buffer_load_dwordx4 v[132:135], v14, s[48:51], s20 offen offset:1024
    buffer_load_dwordx4 v[136:139], v15, s[48:51], s20 offen offset:2048
    buffer_load_dwordx4 v[140:143], v16, s[48:51], s20 offen offset:3072
    s_add_u32 s20, s20, 65536
    s_add_u32 s5, s30, 589824
    buffer_load_dwordx4 v[160:163], v13, s[48:51], s5 offen offset:0
    buffer_load_dwordx4 v[164:167], v14, s[48:51], s5 offen offset:1024
    buffer_load_dwordx4 v[168:171], v15, s[48:51], s5 offen offset:2048
    buffer_load_dwordx4 v[172:175], v16, s[48:51], s5 offen offset:3072
    s_add_u32 s5, s5, 65536
    buffer_load_dwordx4 v[176:179], v13, s[48:51], s5 offen offset:0
    buffer_load_dwordx4 v[180:183], v14, s[48:51], s5 offen offset:1024
    buffer_load_dwordx4 v[184:187], v15, s[48:51], s5 offen offset:2048
    buffer_load_dwordx4 v[188:191], v16, s[48:51], s5 offen offset:3072
    s_add_u32 s5, s26, 126976
    v_add_u32 v4, s5, v7
    ds_write_b128 v4, v[240:243] offset:0
    ds_write_b128 v4, v[244:247] offset:1024
    ds_write_b128 v4, v[248:251] offset:2048
    s_cmp_eq_u32 s101, 1
    s_cbranch_scc1 sk_43
    v_bfe_u32 v4, v0, 2, 1
    v_bfe_u32 v5, v0, 4, 1
    v_xor_b32 v4, v4, v5
    v_add_u32 v4, -1, v4
    v_and_b32 v96, 0x3f803f80, v4
    v_and_b32 v97, 0x3f803f80, v4
    v_and_b32 v98, 0x3f803f80, v4
    v_and_b32 v99, 0x3f803f80, v4
    s_waitcnt lgkmcnt(0)
    ds_read_b64_tr_b16 v[80:81], v42 offset:0
    ds_read_b64_tr_b16 v[82:83], v42 offset:1536
    ds_read_b64_tr_b16 v[84:85], v42 offset:3072
    ds_read_b64_tr_b16 v[86:87], v42 offset:4608
    ds_read_b64_tr_b16 v[88:89], v42 offset:6144
    ds_read_b64_tr_b16 v[90:91], v42 offset:7680
    s_waitcnt lgkmcnt(4)
    v_mfma_f32_16x16x32_bf16 v[24:27], v[96:99], v[80:83], 0
    ds_read_b64_tr_b16 v[92:93], v42 offset:9216
    ds_read_b64_tr_b16 v[94:95], v42 offset:10752
    s_waitcnt lgkmcnt(4)
    v_mfma_f32_16x16x32_bf16 v[24:27], v[96:99], v[84:87], v[24:27]
    ds_read_b64_tr_b16 v[80:81], v42 offset:12288
    ds_read_b64_tr_b16 v[82:83], v42 offset:13824
    s_waitcnt lgkmcnt(4)
    v_mfma_f32_16x16x32_bf16 v[24:27], v[96:99], v[88:91], v[24:27]
    ds_read_b64_tr_b16 v[84:85], v42 offset:15360
    ds_read_b64_tr_b16 v[86:87], v42 offset:16896
    s_waitcnt lgkmcnt(4)
    v_mfma_f32_16x16x32_bf16 v[24:27], v[96:99], v[92:95], v[24:27]
    ds_read_b64_tr_b16 v[88:89], v42 offset:18432
    ds_read_b64_tr_b16 v[90:91], v42 offset:19968
    s_waitcnt lgkmcnt(4)
    v_mfma_f32_16x16x32_bf16 v[24:27], v[96:99], v[80:83], v[24:27]
    ds_read_b64_tr_b16 v[92:93], v42 offset:21504
    ds_read_b64_tr_b16 v[94:95], v42 offset:23040
    s_waitcnt lgkmcnt(4)
    v_mfma_f32_16x16x32_bf16 v[24:27], v[96:99], v[84:87], v[24:27]
    ds_read_b64_tr_b16 v[80:81], v42 offset:24576
    ds_read_b64_tr_b16 v[82:83], v42 offset:26112
    s_waitcnt lgkmcnt(4)
    v_mfma_f32_16x16x32_bf16 v[24:27], v[96:99], v[88:91], v[24:27]
    ds_read_b64_tr_b16 v[84:85], v42 offset:27648
    ds_read_b64_tr_b16 v[86:87], v42 offset:29184
    s_waitcnt lgkmcnt(4)
    v_mfma_f32_16x16x32_bf16 v[24:27], v[96:99], v[92:95], v[24:27]
    ds_read_b64_tr_b16 v[88:89], v42 offset:30720
    ds_read_b64_tr_b16 v[90:91], v42 offset:32256
    s_waitcnt lgkmcnt(4)
    v_mfma_f32_16x16x32_bf16 v[24:27], v[96:99], v[80:83], v[24:27]
    ds_read_b64_tr_b16 v[92:93], v42 offset:33792
    ds_read_b64_tr_b16 v[94:95], v42 offset:35328
    s_waitcnt lgkmcnt(4)
    v_mfma_f32_16x16x32_bf16 v[24:27], v[96:99], v[84:87], v[24:27]
    ds_read_b64_tr_b16 v[80:81], v42 offset:36864
    ds_read_b64_tr_b16 v[82:83], v42 offset:38400
    s_waitcnt lgkmcnt(4)
    v_mfma_f32_16x16x32_bf16 v[24:27], v[96:99], v[88:91], v[24:27]
    ds_read_b64_tr_b16 v[84:85], v42 offset:39936
    ds_read_b64_tr_b16 v[86:87], v42 offset:41472
    s_waitcnt lgkmcnt(4)
    v_mfma_f32_16x16x32_bf16 v[24:27], v[96:99], v[92:95], v[24:27]
    ds_read_b64_tr_b16 v[88:89], v42 offset:43008
    ds_read_b64_tr_b16 v[90:91], v42 offset:44544
    s_waitcnt lgkmcnt(4)
    v_mfma_f32_16x16x32_bf16 v[24:27], v[96:99], v[80:83], v[24:27]
    ds_read_b64_tr_b16 v[92:93], v42 offset:46080
    ds_read_b64_tr_b16 v[94:95], v42 offset:47616
    s_waitcnt lgkmcnt(4)
    v_mfma_f32_16x16x32_bf16 v[24:27], v[96:99], v[84:87], v[24:27]
    ds_read_b64_tr_b16 v[80:81], v42 offset:49152
    ds_read_b64_tr_b16 v[82:83], v42 offset:50688
    s_waitcnt lgkmcnt(4)
    v_mfma_f32_16x16x32_bf16 v[24:27], v[96:99], v[88:91], v[24:27]
    ds_read_b64_tr_b16 v[84:85], v42 offset:52224
    ds_read_b64_tr_b16 v[86:87], v42 offset:53760
    s_waitcnt lgkmcnt(4)
    v_mfma_f32_16x16x32_bf16 v[24:27], v[96:99], v[92:95], v[24:27]
    ds_read_b64_tr_b16 v[88:89], v42 offset:55296
    ds_read_b64_tr_b16 v[90:91], v42 offset:56832
    s_waitcnt lgkmcnt(4)
    v_mfma_f32_16x16x32_bf16 v[24:27], v[96:99], v[80:83], v[24:27]
    ds_read_b64_tr_b16 v[92:93], v42 offset:58368
    ds_read_b64_tr_b16 v[94:95], v42 offset:59904
    s_waitcnt lgkmcnt(4)
    v_mfma_f32_16x16x32_bf16 v[24:27], v[96:99], v[84:87], v[24:27]
    s_waitcnt lgkmcnt(2)
    v_mfma_f32_16x16x32_bf16 v[24:27], v[96:99], v[88:91], v[24:27]
    s_waitcnt lgkmcnt(0)
    v_mfma_f32_16x16x32_bf16 v[24:27], v[96:99], v[92:95], v[24:27]
    s_waitcnt vmcnt(16)
    v_lshlrev_b32 v28, 16, v6
    v_and_b32 v29, 0xffff0000, v6
    v_mul_f32 v28, 0x3fb8aa3b, v28
    v_mul_f32 v29, 0x3fb8aa3b, v29
sk_43:
    v_lshlrev_b32 v4, 3, v1
    v_add_u32 v4, 160256, v4
    ds_write_b64 v4, v[28:29]
    s_waitcnt lgkmcnt(0)
    s_barrier
    s_add_u32 s5, s26, 0
    v_add_u32 v4, s5, v7
    ds_write_b128 v4, v[252:255] offset:0
    ds_write_b128 v4, v[208:211] offset:1024
    ds_write_b128 v4, v[212:215] offset:2048
    s_add_u32 s5, s26, 12288
    v_add_u32 v4, s5, v7
    ds_write_b128 v4, v[216:219] offset:0
    ds_write_b128 v4, v[220:223] offset:1024
    ds_write_b128 v4, v[224:227] offset:2048
    s_waitcnt vmcnt(0)
    s_add_u32 s5, s24, 24576
    v_add_u32 v4, s5, v7
    ds_write_b128 v4, v[112:115] offset:0
    ds_write_b128 v4, v[116:119] offset:1024
    ds_write_b128 v4, v[120:123] offset:2048
    ds_write_b128 v4, v[124:127] offset:3072
    s_add_u32 s5, s24, 40960
    v_add_u32 v4, s5, v7
    ds_write_b128 v4, v[128:131] offset:0
    ds_write_b128 v4, v[132:135] offset:1024
    ds_write_b128 v4, v[136:139] offset:2048
    ds_write_b128 v4, v[140:143] offset:3072
    s_waitcnt lgkmcnt(0)
    s_barrier
    s_cmp_eq_u32 s101, 1
    s_cbranch_scc1 sk_44
    ds_read_b64_tr_b16 v[80:81], v42 offset:61440
    ds_read_b64_tr_b16 v[82:83], v42 offset:62976
    ds_read_b64_tr_b16 v[84:85], v42 offset:64512
    ds_read_b64_tr_b16 v[86:87], v43 offset:512
    ds_read_b64_tr_b16 v[88:89], v43 offset:2048
    ds_read_b64_tr_b16 v[90:91], v43 offset:3584
    s_waitcnt lgkmcnt(4)
    v_mfma_f32_16x16x32_bf16 v[24:27], v[96:99], v[80:83], v[24:27]
    ds_read_b64_tr_b16 v[92:93], v43 offset:5120
    ds_read_b64_tr_b16 v[94:95], v43 offset:6656
    s_waitcnt lgkmcnt(4)
    v_mfma_f32_16x16x32_bf16 v[24:27], v[96:99], v[84:87], v[24:27]
    ds_read_b64_tr_b16 v[80:81], v41 offset:0
    ds_read_b64_tr_b16 v[82:83], v41 offset:1536
    s_waitcnt lgkmcnt(4)
    v_mfma_f32_16x16x32_bf16 v[24:27], v[96:99], v[88:91], v[24:27]
    ds_read_b64_tr_b16 v[84:85], v41 offset:3072
    ds_read_b64_tr_b16 v[86:87], v41 offset:4608
    s_waitcnt lgkmcnt(4)
    v_mfma_f32_16x16x32_bf16 v[24:27], v[96:99], v[92:95], v[24:27]
    ds_read_b64_tr_b16 v[88:89], v41 offset:6144
    ds_read_b64_tr_b16 v[90:91], v41 offset:7680
    s_waitcnt lgkmcnt(4)
    v_mfma_f32_16x16x32_bf16 v[24:27], v[96:99], v[80:83], v[24:27]
    ds_read_b64_tr_b16 v[92:93], v41 offset:9216
    ds_read_b64_tr_b16 v[94:95], v41 offset:10752
    s_waitcnt lgkmcnt(4)
    v_mfma_f32_16x16x32_bf16 v[24:27], v[96:99], v[84:87], v[24:27]
    ds_read_b64_tr_b16 v[80:81], v41 offset:12288
    ds_read_b64_tr_b16 v[82:83], v41 offset:13824
    s_waitcnt lgkmcnt(4)
    v_mfma_f32_16x16x32_bf16 v[24:27], v[96:99], v[88:91], v[24:27]
    ds_read_b64_tr_b16 v[84:85], v41 offset:15360
    ds_read_b64_tr_b16 v[86:87], v41 offset:16896
    s_waitcnt lgkmcnt(4)
    v_mfma_f32_16x16x32_bf16 v[24:27], v[96:99], v[92:95], v[24:27]
    ds_read_b64_tr_b16 v[88:89], v41 offset:18432
    ds_read_b64_tr_b16 v[90:91], v41 offset:19968
    s_waitcnt lgkmcnt(4)
    v_mfma_f32_16x16x32_bf16 v[24:27], v[96:99], v[80:83], v[24:27]
    ds_read_b64_tr_b16 v[92:93], v41 offset:21504
    ds_read_b64_tr_b16 v[94:95], v41 offset:23040
    s_waitcnt lgkmcnt(4)
    v_mfma_f32_16x16x32_bf16 v[24:27], v[96:99], v[84:87], v[24:27]
    s_waitcnt lgkmcnt(2)
    v_mfma_f32_16x16x32_bf16 v[24:27], v[96:99], v[88:91], v[24:27]
    s_waitcnt lgkmcnt(0)
    v_mfma_f32_16x16x32_bf16 v[24:27], v[96:99], v[92:95], v[24:27]
    s_mul_i32 s6, s17, 768
    s_lshl_b32 s5, s29, 8
    s_add_u32 s6, s6, s5
    s_add_u32 s6, s6, 0x1080000
    v_lshlrev_b32 v4, 3, v2
    s_mov_b32 s5, 0
csp_45:
    buffer_load_dwordx2 v[56:57], v4, s[12:15], s6 offen sc1
    s_add_u32 s5, s5, 1
    s_cmp_gt_u32 s5, 262144
    s_waitcnt vmcnt(0)
    s_cbranch_scc1 csd_46
    v_cmp_ne_u32 vcc, s100, v57
    s_cbranch_vccnz csp_45
csd_46:
    v_mov_b32 v12, v56
    s_nop 7
sk_44:
    s_lshl_b32 s5, s29, 7
    s_add_u32 s5, s5, 159744
    v_lshlrev_b32 v4, 2, v2
    v_add_u32 v4, s5, v4
    ds_write_b32 v4, v24
    ds_write_b32 v4, v12 offset:1024
    s_waitcnt lgkmcnt(0)
    s_barrier
    s_add_u32 m0, s24, 139264
    s_nop 0
    buffer_load_dwordx4 v13, s[48:51], s20 offen offset:0  lds
    buffer_load_dwordx4 v14, s[48:51], s20 offen offset:1024  lds
    buffer_load_dwordx4 v15, s[48:51], s20 offen offset:2048  lds
    buffer_load_dwordx4 v16, s[48:51], s20 offen offset:3072  lds
    s_add_u32 s20, s20, 65536
    s_add_u32 m0, s24, 57344
    s_nop 0
    buffer_load_dwordx4 v13, s[48:51], s20 offen offset:0  lds
    buffer_load_dwordx4 v14, s[48:51], s20 offen offset:1024  lds
    buffer_load_dwordx4 v15, s[48:51], s20 offen offset:2048  lds
    buffer_load_dwordx4 v16, s[48:51], s20 offen offset:3072  lds
    s_add_u32 s20, s20, 65536
    s_add_u32 m0, s24, 73728
    s_nop 0
    buffer_load_dwordx4 v13, s[48:51], s20 offen offset:0  lds
    buffer_load_dwordx4 v14, s[48:51], s20 offen offset:1024  lds
    buffer_load_dwordx4 v15, s[48:51], s20 offen offset:2048  lds
    buffer_load_dwordx4 v16, s[48:51], s20 offen offset:3072  lds
    s_add_u32 s20, s20, 65536
    s_barrier
    s_add_u32 m0, s24, 90112
    s_nop 0
    buffer_load_dwordx4 v13, s[48:51], s20 offen offset:0  lds
    buffer_load_dwordx4 v14, s[48:51], s20 offen offset:1024  lds
    buffer_load_dwordx4 v15, s[48:51], s20 offen offset:2048  lds
    buffer_load_dwordx4 v16, s[48:51], s20 offen offset:3072  lds
    s_add_u32 s20, s20, 65536
    s_add_u32 m0, s24, 106496
    s_nop 0
    buffer_load_dwordx4 v13, s[48:51], s20 offen offset:0  lds
    buffer_load_dwordx4 v14, s[48:51], s20 offen offset:1024  lds
    buffer_load_dwordx4 v15, s[48:51], s20 offen offset:2048  lds
    buffer_load_dwordx4 v16, s[48:51], s20 offen offset:3072  lds
    s_add_u32 s20, s20, 65536
    s_add_u32 m0, s24, 122880
    s_nop 0
    buffer_load_dwordx4 v13, s[48:51], s20 offen offset:0  lds
    buffer_load_dwordx4 v14, s[48:51], s20 offen offset:1024  lds
    buffer_load_dwordx4 v15, s[48:51], s20 offen offset:2048  lds
    buffer_load_dwordx4 v16, s[48:51], s20 offen offset:3072  lds
    s_add_u32 s20, s20, 65536
    s_add_u32 m0, s24, 0
    s_nop 0
    buffer_load_dwordx4 v13, s[48:51], s20 offen offset:0  lds
    buffer_load_dwordx4 v14, s[48:51], s20 offen offset:1024  lds
    buffer_load_dwordx4 v15, s[48:51], s20 offen offset:2048  lds
    buffer_load_dwordx4 v16, s[48:51], s20 offen offset:3072  lds
    s_add_u32 s20, s20, 65536
    s_waitcnt vmcnt(20) lgkmcnt(0)
    s_barrier
    s_waitcnt vmcnt(0)
    s_barrier
    s_add_u32 s5, s24, 16384
    v_add_u32 v4, s5, v7
    ds_write_b128 v4, v[160:163] offset:0
    ds_write_b128 v4, v[164:167] offset:1024
    ds_write_b128 v4, v[168:171] offset:2048
    ds_write_b128 v4, v[172:175] offset:3072
    s_add_u32 s5, s24, 32768
    v_add_u32 v4, s5, v7
    ds_write_b128 v4, v[176:179] offset:0
    ds_write_b128 v4, v[180:183] offset:1024
    ds_write_b128 v4, v[184:187] offset:2048
    ds_write_b128 v4, v[188:191] offset:3072
    s_cmp_eq_u32 s101, 1
    s_cbranch_scc1 ac_lfinal
    s_add_u32 m0, s26, 139264
    s_nop 0
    buffer_load_dwordx4 v20, s[52:55], s28 offen offset:0  lds
    buffer_load_dwordx4 v21, s[52:55], s28 offen offset:1024  lds
    buffer_load_dwordx4 v22, s[52:55], s28 offen offset:2048  lds
    s_add_u32 s28, s28, 196608
    s_waitcnt vmcnt(3) lgkmcnt(0)
    s_barrier
    s_add_u32 m0, s26, 49152
    s_nop 0
    buffer_load_dwordx4 v20, s[52:55], s28 offen offset:0  lds
    buffer_load_dwordx4 v21, s[52:55], s28 offen offset:1024  lds
    buffer_load_dwordx4 v22, s[52:55], s28 offen offset:2048  lds
    s_add_u32 s28, s28, 196608
    s_add_u32 m0, s26, 61440
    s_nop 0
    buffer_load_dwordx4 v20, s[52:55], s28 offen offset:0  lds
    buffer_load_dwordx4 v21, s[52:55], s28 offen offset:1024  lds
    buffer_load_dwordx4 v22, s[52:55], s28 offen offset:2048  lds
    s_add_u32 s28, s28, 196608
    s_add_u32 m0, s26, 73728
    s_nop 0
    buffer_load_dwordx4 v20, s[52:55], s28 offen offset:0  lds
    buffer_load_dwordx4 v21, s[52:55], s28 offen offset:1024  lds
    buffer_load_dwordx4 v22, s[52:55], s28 offen offset:2048  lds
    s_add_u32 s28, s28, 196608
    s_add_u32 m0, s26, 86016
    s_nop 0
    buffer_load_dwordx4 v20, s[52:55], s28 offen offset:0  lds
    buffer_load_dwordx4 v21, s[52:55], s28 offen offset:1024  lds
    buffer_load_dwordx4 v22, s[52:55], s28 offen offset:2048  lds
    s_add_u32 s28, s28, 196608
    s_barrier
    s_add_u32 m0, s26, 98304
    s_nop 0
    buffer_load_dwordx4 v20, s[52:55], s28 offen offset:0  lds
    buffer_load_dwordx4 v21, s[52:55], s28 offen offset:1024  lds
    buffer_load_dwordx4 v22, s[52:55], s28 offen offset:2048  lds
    s_add_u32 s28, s28, 196608
    s_waitcnt vmcnt(0) lgkmcnt(0)
    s_barrier
    s_add_u32 m0, s26, 110592
    s_nop 0
    buffer_load_dwordx4 v20, s[52:55], s28 offen offset:0  lds
    buffer_load_dwordx4 v21, s[52:55], s28 offen offset:1024  lds
    buffer_load_dwordx4 v22, s[52:55], s28 offen offset:2048  lds
    s_add_u32 s28, s28, 196608
    s_add_u32 m0, s26, 122880
    s_nop 0
    buffer_load_dwordx4 v20, s[52:55], s28 offen offset:0  lds
    buffer_load_dwordx4 v21, s[52:55], s28 offen offset:1024  lds
    buffer_load_dwordx4 v22, s[52:55], s28 offen offset:2048  lds
    s_add_u32 s28, s28, 196608
    s_waitcnt vmcnt(0)
    s_barrier
    s_branch ac_second
ac_lfinal:
    s_waitcnt vmcnt(0) lgkmcnt(0)
    s_barrier
    s_barrier
    s_barrier
    s_endpgm
ac_slow:
    s_mov_b32 s34, 1
    v_mov_b32 v43, 0xff800000
    s_add_u32 s30, s19, 0x400000
    s_mov_b32 s29, 0
ac_maxloop:
    buffer_load_dwordx4 v[112:115], v7, s[12:15], s30 offen sc1
    s_add_u32 s30, s30, 1024
    s_waitcnt vmcnt(0)
    v_mfma_f32_32x32x16_bf16 v[48:63], v[112:115], v[236:239], 0
    s_nop 15
    v_max3_f32 v43, v48, v49, v43
    v_max3_f32 v43, v50, v51, v43
    v_max3_f32 v43, v52, v53, v43
    v_max3_f32 v43, v54, v55, v43
    v_max3_f32 v43, v56, v57, v43
    v_max3_f32 v43, v58, v59, v43
    v_max3_f32 v43, v60, v61, v43
    v_max3_f32 v43, v62, v63, v43
    s_add_u32 s29, s29, 1
    s_cmp_lt_u32 s29, 64
    s_cbranch_scc1 ac_maxloop
    v_mov_b32 v42, v43
    s_nop 1
    v_permlane32_swap_b32 v42, v43
    s_nop 1
    v_max_f32 v43, v42, v43
    v_sub_f32 v80, 0, v43
    v_mov_b32 v96, 0
    v_sub_f32 v81, 0, v43
    v_mov_b32 v97, 0
    v_sub_f32 v82, 0, v43
    v_mov_b32 v98, 0
    v_sub_f32 v83, 0, v43
    v_mov_b32 v99, 0
    v_sub_f32 v84, 0, v43
    v_mov_b32 v100, 0
    v_sub_f32 v85, 0, v43
    v_mov_b32 v101, 0
    v_sub_f32 v86, 0, v43
    v_mov_b32 v102, 0
    v_sub_f32 v87, 0, v43
    v_mov_b32 v103, 0
    v_sub_f32 v88, 0, v43
    v_mov_b32 v104, 0
    v_sub_f32 v89, 0, v43
    v_mov_b32 v105, 0
    v_sub_f32 v90, 0, v43
    v_mov_b32 v106, 0
    v_sub_f32 v91, 0, v43
    v_mov_b32 v107, 0
    v_sub_f32 v92, 0, v43
    v_mov_b32 v108, 0
    v_sub_f32 v93, 0, v43
    v_mov_b32 v109, 0
    v_sub_f32 v94, 0, v43
    v_mov_b32 v110, 0
    v_sub_f32 v95, 0, v43
    v_mov_b32 v111, 0
    s_mul_i32 s31, s18, 2304
    s_add_u32 s31, s31, 126976
    s_add_u32 s32, s31, 1024
    v_and_b32 v4, 1, v0
    v_xor_b32 v4, 1, v4
    v_mul_u32_u24 v64, 0x3f80, v4
    v_mov_b32 v65, 0
    v_mov_b32 v67, 0
    v_mov_b32 v66, v64
    v_add_u32 v68, s32, v7
    ds_write_b128 v68, v[64:67] offset:0
    v_bfe_u32 v4, v0, 2, 2
    v_lshlrev_b32 v4, 5, v4
    v_and_b32 v5, 3, v0
    v_lshl_add_u32 v4, v5, 3, v4
    v_bfe_u32 v5, v0, 4, 1
    v_cmp_eq_u32 vcc, 1, v5
    v_add_u32 v6, s32, v4
    v_add_u32 v6, 128, v6
    v_lshl_add_u32 v4, v3, 8, v4
    v_add_u32 v4, s31, v4
    v_cndmask_b32 v32, v4, v6, vcc
    s_mov_b32 m0, s31
    s_add_u32 s30, s19, 0x400000
    s_add_u32 s31, s19, 0x600000
    s_mov_b32 s29, 0
ac_slowloop:
    buffer_load_dwordx4 v[112:115], v7, s[12:15], s30 offen sc1
    buffer_load_dwordx4 v7, s[12:15], s31 offen sc1 lds
    s_add_u32 s30, s30, 1024
    s_add_u32 s31, s31, 1024
    s_waitcnt vmcnt(0) lgkmcnt(0)
    ds_read_b64_tr_b16 v[144:145], v32 offset:0
    ds_read_b64_tr_b16 v[146:147], v32 offset:128
    ds_read_b64_tr_b16 v[148:149], v32 offset:512
    ds_read_b64_tr_b16 v[150:151], v32 offset:640
    v_mfma_f32_32x32x16_bf16 v[48:63], v[112:115], v[236:239], v[80:95]
    s_nop 15
    v_exp_f32 v48, v48
    v_exp_f32 v49, v49
    v_exp_f32 v50, v50
    v_exp_f32 v51, v51
    v_exp_f32 v52, v52
    v_exp_f32 v53, v53
    v_exp_f32 v54, v54
    v_exp_f32 v55, v55
    v_exp_f32 v56, v56
    v_exp_f32 v57, v57
    v_exp_f32 v58, v58
    v_exp_f32 v59, v59
    v_exp_f32 v60, v60
    v_exp_f32 v61, v61
    v_exp_f32 v62, v62
    v_exp_f32 v63, v63
    s_waitcnt lgkmcnt(0)
    s_nop 1
    v_smfmac_f32_32x32x32_bf16 v[96:111], v[144:147], v[48:55], v40
    v_smfmac_f32_32x32x32_bf16 v[96:111], v[148:151], v[56:63], v40
    s_add_u32 s29, s29, 1
    s_cmp_lt_u32 s29, 64
    s_cbranch_scc1 ac_slowloop
    s_nop 15
    s_branch ac_fin
code_end:
.section .rodata,"a"
.p2align 6
.amdhsa_kernel interleave_layers__softmax_full_mha__dense_activation_mish__prompt_kernel
  .amdhsa_next_free_vgpr 256
  .amdhsa_next_free_sgpr 102
  .amdhsa_accum_offset 256
  .amdhsa_group_segment_fixed_size 0
  .amdhsa_kernarg_size 80
  .amdhsa_user_sgpr_count 2
  .amdhsa_user_sgpr_kernarg_segment_ptr 1
  .amdhsa_system_sgpr_workgroup_id_x 1
.end_amdhsa_kernel
```
